```python
import torch

def _softmax(x, axis=-1):
    return torch.softmax(x, dim=axis)
def _gelu(x):
    return torch.nn.functional.gelu(x, approximate="tanh")
def _silu(x):
    return torch.nn.functional.silu(x)
def _sigmoid(x):
    return torch.sigmoid(x)
def _layernorm(x, axis=-1, eps=1e-5):
    m = x.mean(dim=axis, keepdim=True)
    v = x.var(dim=axis, keepdim=True, unbiased=False)
    return (x - m) / torch.sqrt(v + eps)
def _scatter_add(tgt, idx, src, axis=0):
    return tgt.clone().index_add_(axis, idx, src)
def _segment_sum(src, seg, n):
    out = torch.zeros((n,) + src.shape[1:], dtype=src.dtype)
    return out.index_add_(0, seg, src)
def _pad(x, pw):
    flat = tuple(v for pair in reversed(pw) for v in pair)
    return torch.nn.functional.pad(x, flat)

kernel_name = 'sequential_preLN__ssm_conv_h3__glu_gated_swiglu__prompt'

def setup_inputs():

    _w = (lambda a: (lambda t: t.to(torch.bfloat16) if t.is_floating_point() else t)(torch.as_tensor(a)))
    def _A_setup():
        B, S, D = 1, 2048, 512
        ks = 4
        return {
            "q": _w((lambda *s: torch.randn(*s, dtype=torch.bfloat16) * 0.05)(B, S, D)),
            "k": _w((lambda *s: torch.randn(*s, dtype=torch.bfloat16) * 0.2)(B, S, D)),
            "v": _w((lambda *s: torch.randn(*s, dtype=torch.bfloat16) * 0.2)(B, S, D)),
            "shift_k": _w((lambda *s: torch.randn(*s, dtype=torch.bfloat16) * 0.2)(D, ks) * 0.5),
            "ssm_k": _w((lambda *s: torch.randn(*s, dtype=torch.bfloat16) * 0.4)(D, S) * (1.0 / S ** 0.5)),
            "ssm_D": _w((lambda *s: torch.randn(*s, dtype=torch.bfloat16) * 0.2)(D)),
        }
    _A_in = _A_setup()

    def _B_setup():
        B, S, D, F = 1, 2048, 512, 1792
        return {
            "x": _w((lambda *s: torch.randn(*s, dtype=torch.bfloat16) * 0.05)(B, S, D)),
            "w1": _w((lambda *s: torch.randn(*s, dtype=torch.bfloat16) * 0.2)(D, F) * (2.0 / D) ** 0.5),
            "w3": _w((lambda *s: torch.randn(*s, dtype=torch.bfloat16) * 0.2)(D, F) * (2.0 / D) ** 0.5),
            "w2": _w((lambda *s: torch.randn(*s, dtype=torch.bfloat16) * 0.2)(F, D) * (2.0 / F) ** 0.5),
        }
    _B_in = _B_setup()

    return {
        "A_q": _A_in["q"],
        "A_k": _A_in["k"],
        "A_v": _A_in["v"],
        "A_shift_k": _A_in["shift_k"],
        "A_ssm_k": _A_in["ssm_k"],
        "A_ssm_D": _A_in["ssm_D"],
        "B_x": _B_in["x"],
        "B_w1": _B_in["w1"],
        "B_w3": _B_in["w3"],
        "B_w2": _B_in["w2"],
    }

def reference(A_q, A_k, A_v, A_shift_k, A_ssm_k, A_ssm_D, B_x, B_w1, B_w3, B_w2):
    def _A_ref(q, k, v, shift_k, ssm_k, ssm_D):
        B, S, D = q.shape
        ks = shift_k.shape[-1]
        k_pad = _pad(k, ((0, 0), (ks - 1, 0), (0, 0)))
        k_shift = torch.zeros_like(k)
        for t in range(ks):
            k_shift = k_shift + k_pad[:, t:t + S, :] * shift_k[:, ks - 1 - t][None, None, :]
        kv = k_shift * v
        L = 2 * S
        kv_pad = _pad(kv, ((0, 0), (0, S), (0, 0)))
        kf_pad = _pad(ssm_k, ((0, 0), (0, S)))
        kv_f = (lambda x, axes=(-2,-1): torch.fft.rfft2(x.float(), dim=axes))(kv_pad[:, None, :, :], axes=(1, 2))
        kf_f = (lambda x, axes=(-2,-1): torch.fft.rfft2(x.float(), dim=axes))(kf_pad[:, None, :], axes=(1, 2))
        kf_f = (lambda x, *d: x.permute(*d))(kf_f, 1, 2, 0)
        y_f = kv_f * kf_f[None, :, :, :]
        y = (lambda x, s, axes=(-2,-1): torch.fft.irfft2(x, s=s, dim=axes).to(torch.bfloat16))(y_f, (1, L), axes=(1, 2))[:, 0, :S, :]
        y = y + kv * ssm_D[None, None, :]
        return q * y

    def _B_ref(x, w1, w3, w2):
        gate = torch.einsum("bsd,df->bsf", x, w1)
        up = torch.einsum("bsd,df->bsf", x, w3)
        h = _silu(gate) * up
        out = torch.einsum("bsf,fd->bsd", h, w2)
        return out

    x = A_q
    h = x + _A_ref(_layernorm(x, axis=-1), A_k, A_v, A_shift_k, A_ssm_k, A_ssm_D)
    h2 = h + _B_ref(_layernorm(h, axis=-1), B_w1, B_w3, B_w2)
    return h2
```

```asm
; @launch grid=(256,1,1) block=(512,1,1) lds=163840
.amdgcn_target "amdgcn-amd-amdhsa--gfx950"
.text
.globl sequential_preLN__ssm_conv_h3__glu_gated_swiglu__prompt_kernel
.p2align 8
.type sequential_preLN__ssm_conv_h3__glu_gated_swiglu__prompt_kernel,@function
sequential_preLN__ssm_conv_h3__glu_gated_swiglu__prompt_kernel:
L_begin:
  s_cmp_ge_u32 s2, 256
  s_cbranch_scc1 L_end
  s_load_dwordx16 s[16:31], s[0:1], 0
  s_load_dwordx8 s[32:39], s[0:1], 64
  s_load_dwordx2 s[40:41], s[0:1], 96
  v_lshrrev_b32 v1, 6, v0
  s_mov_b32 s64, 0xffff0000
  v_readfirstlane_b32 s3, v1
  s_mov_b32 s65, 0x05040100
  s_mov_b32 s66, 0x07060302
  s_and_b32 s6, s2, 7
  s_lshl_b32 s6, s6, 5
  s_lshr_b32 s7, s2, 3
  s_add_u32 s73, s6, s7
  s_waitcnt lgkmcnt(0)
  s_mov_b32 s44, s40
  s_mov_b32 s45, s41
  s_mov_b32 s46, 26214400
  s_mov_b32 s47, 0x00020000
  s_add_u32 s6, s40, 14450688
  s_addc_u32 s7, s41, 0
  s_load_dword s74, s[6:7], 0
  s_cmp_ge_u32 s3, 4
  s_cbranch_scc1 L_roleM
  s_mov_b32 s60, s22
  s_mov_b32 s61, s23
  s_mov_b32 s62, 4096
  s_mov_b32 s63, 0x00020000
  s_and_b32 s4, s2, 7
  s_lshl_b32 s6, s4, 9
  v_and_b32 v7, 63, v0
  v_lshlrev_b32 v44, 3, v7
  buffer_load_dwordx2 v[46:47], v44, s[60:63], s6 offen nt
  s_mov_b32 s48, s18
  s_mov_b32 s49, s19
  s_mov_b32 s50, 2097152
  s_mov_b32 s51, 0x00020000
  s_lshr_b32 s5, s2, 3
  s_lshl_b32 s6, s5, 16
  s_lshl_b32 s7, s4, 7
  s_add_u32 s6, s6, s7
  v_and_b32 v1, 7, v0
  v_lshrrev_b32 v2, 3, v0
  v_lshlrev_b32 v3, 11, v2
  v_lshl_add_u32 v3, v1, 4, v3
  v_add_u32 v3, s6, v3
  buffer_load_dwordx4 v[20:23], v3, s[48:51], 0 offen nt
  buffer_load_dwordx4 v[24:27], v3, s[48:51], 0 offen offset:1024 nt
  s_mov_b32 s52, s20
  s_mov_b32 s53, s21
  s_mov_b32 s54, 2097152
  s_mov_b32 s55, 0x00020000
  buffer_load_dwordx4 v[28:31], v3, s[52:55], 0 offen nt
  buffer_load_dwordx4 v[32:35], v3, s[52:55], 0 offen offset:1024 nt
  v_subrev_u32 v4, 3072, v3
  v_subrev_u32 v5, 2048, v3
  v_subrev_u32 v6, 1024, v3
  buffer_load_dwordx4 v[16:19], v6, s[48:51], 0 offen nt
  buffer_load_dwordx4 v[12:15], v5, s[48:51], 0 offen nt
  buffer_load_dwordx4 v[8:11], v4, s[48:51], 0 offen nt
  s_mov_b32 s56, s16
  s_mov_b32 s57, s17
  s_mov_b32 s58, 2097152
  s_mov_b32 s59, 0x00020000
  v_lshlrev_b32 v60, 2, v1
  v_sub_u32 v61, 31, v2
  v_xor_b32 v61, v61, v60
  v_xor_b32 v62, v2, v60
  v_lshlrev_b32 v63, 10, v1
  v_lshl_add_u32 v61, v61, 2, v63
  v_lshl_add_u32 v62, v62, 2, v63
  v_add_u32 v61, 100352, v61
  v_add_u32 v62, 108544, v62
  v_lshrrev_b32 v63, 6, v0
  v_xor_b32 v63, v63, v1
  v_lshlrev_b32 v63, 4, v63
  v_lshl_add_u32 v63, v2, 7, v63
  v_add_u32 v63, 100352, v63
  v_xor_b32 v64, 64, v63
  v_add_u32 v64, 4096, v64
  s_lshl_b32 s7, s4, 6
  v_add_u32 v65, s7, v2
  s_movk_i32 s8, 4352
  v_mul_lo_u32 v65, v65, s8
  v_lshl_add_u32 v65, v1, 4, v65
  s_lshl_b32 s9, s5, 7
  s_sub_u32 s10, 3968, s9
  s_add_u32 s11, s10, 139264
  s_add_u32 s12, s9, 2359296
  s_add_u32 s13, s12, 139264
  s_barrier
  buffer_load_dwordx4 v[36:39], v3, s[56:59], 0 offen nt
  buffer_load_dwordx4 v[40:43], v3, s[56:59], 0 offen offset:1024 nt
  s_waitcnt lgkmcnt(0)
  s_mul_i32 s74, s74, 0x9E3779B1
  s_add_u32 s74, s74, 0x7F4A7C15
  s_not_b32 s75, s74
  s_getreg_b32 s15, hwreg(HW_REG_XCC_ID, 0, 4)
  s_mov_b32 s14, s74
  s_add_u32 s15, s15, 1
  s_sub_u32 s15, s75, s15
  s_mul_i32 s6, s3, 1152
  s_add_u32 s6, s6, 126976
  v_lshrrev_b32 v44, 3, v7
  v_mul_u32_u24 v44, 144, v44
  v_bfe_u32 v45, v7, 1, 2
  v_lshl_add_u32 v44, v45, 5, v44
  v_and_b32 v45, 1, v7
  v_lshl_add_u32 v44, v45, 2, v44
  v_add_u32 v44, s6, v44
  v_mul_u32_u24 v7, 144, v1
  v_add_u32 v7, s6, v7
  s_waitcnt vmcnt(9)
  v_lshlrev_b32 v48, 16, v46
  v_and_b32 v49, s64, v46
  v_lshlrev_b32 v50, 16, v47
  v_and_b32 v51, s64, v47
  ds_write2_b32 v44, v48, v49 offset0:0 offset1:2
  ds_write2_b32 v44, v50, v51 offset0:4 offset1:6
  ds_read_b128 v[112:115], v7 offset:0
  ds_read_b128 v[116:119], v7 offset:16
  ds_read_b128 v[120:123], v7 offset:32
  ds_read_b128 v[124:127], v7 offset:48
  ds_read_b128 v[128:131], v7 offset:64
  ds_read_b128 v[132:135], v7 offset:80
  ds_read_b128 v[136:139], v7 offset:96
  ds_read_b128 v[140:143], v7 offset:112
  s_waitcnt vmcnt(2) lgkmcnt(0)
  v_lshlrev_b32 v76, 16, v8
  v_and_b32 v77, s64, v8
  v_lshlrev_b32 v78, 16, v12
  v_and_b32 v79, s64, v12
  v_lshlrev_b32 v80, 16, v16
  v_and_b32 v81, s64, v16
  v_lshlrev_b32 v82, 16, v20
  v_and_b32 v83, s64, v20
  v_lshlrev_b32 v84, 16, v24
  v_and_b32 v85, s64, v24
  v_lshlrev_b32 v86, 16, v28
  v_and_b32 v87, s64, v28
  v_lshlrev_b32 v88, 16, v32
  v_and_b32 v89, s64, v32
  v_pk_mul_f32 v[90:91], v[118:119], v[76:77]
  v_pk_mul_f32 v[92:93], v[118:119], v[78:79]
  v_pk_fma_f32 v[90:91], v[116:117], v[78:79], v[90:91]
  v_pk_fma_f32 v[92:93], v[116:117], v[80:81], v[92:93]
  v_pk_fma_f32 v[90:91], v[114:115], v[80:81], v[90:91]
  v_pk_fma_f32 v[92:93], v[114:115], v[82:83], v[92:93]
  v_pk_fma_f32 v[90:91], v[112:113], v[82:83], v[90:91]
  v_pk_fma_f32 v[92:93], v[112:113], v[84:85], v[92:93]
  v_pk_mul_f32 v[90:91], v[90:91], v[86:87]
  v_pk_mul_f32 v[92:93], v[92:93], v[88:89]
  v_cvt_pk_bf16_f32 v94, v92, v90
  v_cvt_pk_bf16_f32 v95, v93, v91
  ds_write2_b32 v61, v94, v95 offset0:0 offset1:32
  v_lshlrev_b32 v76, 16, v9
  v_and_b32 v77, s64, v9
  v_lshlrev_b32 v78, 16, v13
  v_and_b32 v79, s64, v13
  v_lshlrev_b32 v80, 16, v17
  v_and_b32 v81, s64, v17
  v_lshlrev_b32 v82, 16, v21
  v_and_b32 v83, s64, v21
  v_lshlrev_b32 v84, 16, v25
  v_and_b32 v85, s64, v25
  v_lshlrev_b32 v86, 16, v29
  v_and_b32 v87, s64, v29
  v_lshlrev_b32 v88, 16, v33
  v_and_b32 v89, s64, v33
  v_pk_mul_f32 v[90:91], v[126:127], v[76:77]
  v_pk_mul_f32 v[92:93], v[126:127], v[78:79]
  v_pk_fma_f32 v[90:91], v[124:125], v[78:79], v[90:91]
  v_pk_fma_f32 v[92:93], v[124:125], v[80:81], v[92:93]
  v_pk_fma_f32 v[90:91], v[122:123], v[80:81], v[90:91]
  v_pk_fma_f32 v[92:93], v[122:123], v[82:83], v[92:93]
  v_pk_fma_f32 v[90:91], v[120:121], v[82:83], v[90:91]
  v_pk_fma_f32 v[92:93], v[120:121], v[84:85], v[92:93]
  v_pk_mul_f32 v[90:91], v[90:91], v[86:87]
  v_pk_mul_f32 v[92:93], v[92:93], v[88:89]
  v_cvt_pk_bf16_f32 v96, v92, v90
  v_cvt_pk_bf16_f32 v97, v93, v91
  ds_write2_b32 v61, v96, v97 offset0:64 offset1:96
  v_lshlrev_b32 v76, 16, v10
  v_and_b32 v77, s64, v10
  v_lshlrev_b32 v78, 16, v14
  v_and_b32 v79, s64, v14
  v_lshlrev_b32 v80, 16, v18
  v_and_b32 v81, s64, v18
  v_lshlrev_b32 v82, 16, v22
  v_and_b32 v83, s64, v22
  v_lshlrev_b32 v84, 16, v26
  v_and_b32 v85, s64, v26
  v_lshlrev_b32 v86, 16, v30
  v_and_b32 v87, s64, v30
  v_lshlrev_b32 v88, 16, v34
  v_and_b32 v89, s64, v34
  v_pk_mul_f32 v[90:91], v[134:135], v[76:77]
  v_pk_mul_f32 v[92:93], v[134:135], v[78:79]
  v_pk_fma_f32 v[90:91], v[132:133], v[78:79], v[90:91]
  v_pk_fma_f32 v[92:93], v[132:133], v[80:81], v[92:93]
  v_pk_fma_f32 v[90:91], v[130:131], v[80:81], v[90:91]
  v_pk_fma_f32 v[92:93], v[130:131], v[82:83], v[92:93]
  v_pk_fma_f32 v[90:91], v[128:129], v[82:83], v[90:91]
  v_pk_fma_f32 v[92:93], v[128:129], v[84:85], v[92:93]
  v_pk_mul_f32 v[90:91], v[90:91], v[86:87]
  v_pk_mul_f32 v[92:93], v[92:93], v[88:89]
  v_cvt_pk_bf16_f32 v98, v92, v90
  v_cvt_pk_bf16_f32 v99, v93, v91
  ds_write2_b32 v61, v98, v99 offset0:128 offset1:160
  v_lshlrev_b32 v76, 16, v11
  v_and_b32 v77, s64, v11
  v_lshlrev_b32 v78, 16, v15
  v_and_b32 v79, s64, v15
  v_lshlrev_b32 v80, 16, v19
  v_and_b32 v81, s64, v19
  v_lshlrev_b32 v82, 16, v23
  v_and_b32 v83, s64, v23
  v_lshlrev_b32 v84, 16, v27
  v_and_b32 v85, s64, v27
  v_lshlrev_b32 v86, 16, v31
  v_and_b32 v87, s64, v31
  v_lshlrev_b32 v88, 16, v35
  v_and_b32 v89, s64, v35
  v_pk_mul_f32 v[90:91], v[142:143], v[76:77]
  v_pk_mul_f32 v[92:93], v[142:143], v[78:79]
  v_pk_fma_f32 v[90:91], v[140:141], v[78:79], v[90:91]
  v_pk_fma_f32 v[92:93], v[140:141], v[80:81], v[92:93]
  v_pk_fma_f32 v[90:91], v[138:139], v[80:81], v[90:91]
  v_pk_fma_f32 v[92:93], v[138:139], v[82:83], v[92:93]
  v_pk_fma_f32 v[90:91], v[136:137], v[82:83], v[90:91]
  v_pk_fma_f32 v[92:93], v[136:137], v[84:85], v[92:93]
  v_pk_mul_f32 v[90:91], v[90:91], v[86:87]
  v_pk_mul_f32 v[92:93], v[92:93], v[88:89]
  v_cvt_pk_bf16_f32 v100, v92, v90
  v_cvt_pk_bf16_f32 v101, v93, v91
  ds_write2_b32 v61, v100, v101 offset0:192 offset1:224
  s_waitcnt lgkmcnt(0)
  v_mov_b32 v66, 161748
  v_mov_b32 v67, 1
  s_mov_b64 exec, 1
  ds_add_u32 v66, v67
  s_mov_b64 exec, -1
  v_mov_b32 v66, 161748
L_aw_1:
  ds_read_b32 v67, v66
  s_waitcnt lgkmcnt(0)
  v_readfirstlane_b32 s6, v67
  s_nop 1
  s_cmp_ge_u32 s6, 4
  s_cbranch_scc1 L_aw_1_ok
  s_branch L_aw_1
L_aw_1_ok:
  ds_read_b128 v[8:11], v63
  ds_read_b128 v[12:15], v64
  s_waitcnt lgkmcnt(1)
  buffer_store_dwordx4 v[8:11], v65, s[44:47], s10 offen
  s_waitcnt lgkmcnt(0)
  buffer_store_dwordx4 v[12:15], v65, s[44:47], s11 offen
  s_lshl_b32 s6, s73, 3
  s_add_u32 s9, s6, s3
  s_waitcnt vmcnt(0)
  v_mov_b32 v8, s14
  v_mov_b32 v9, s15
  v_mov_b32 v10, 0
  s_lshl_b32 s6, s9, 4
  s_add_u32 s6, s6, 14483456
  s_mov_b64 exec, 1
  buffer_store_dwordx2 v[8:9], v10, s[44:47], s6 offen
  s_mov_b64 exec, -1
  v_perm_b32 v102, v40, v36, s65
  v_perm_b32 v103, v40, v36, s66
  ds_write2_b32 v62, v102, v103 offset0:0 offset1:32
  v_perm_b32 v104, v41, v37, s65
  v_perm_b32 v105, v41, v37, s66
  ds_write2_b32 v62, v104, v105 offset0:64 offset1:96
  v_perm_b32 v106, v42, v38, s65
  v_perm_b32 v107, v42, v38, s66
  ds_write2_b32 v62, v106, v107 offset0:128 offset1:160
  v_perm_b32 v108, v43, v39, s65
  v_perm_b32 v109, v43, v39, s66
  ds_write2_b32 v62, v108, v109 offset0:192 offset1:224
  v_mov_b32 v66, 161760
  v_mov_b32 v67, 1
  s_mov_b64 exec, 1
  ds_add_u32 v66, v67
  s_mov_b64 exec, -1
  v_and_b32 v1, 63, v0
  s_cmp_lg_u32 s3, 0
  s_cbranch_scc1 L_s1_2_x
  v_and_b32 v10, 31, v1
  v_lshlrev_b32 v10, 7, v10
  v_lshrrev_b32 v11, 5, v1
  s_bfe_u32 s10, s73, 0x20002
  s_lshl_b32 s10, s10, 4
  s_sub_u32 s11, 229376, s10
  v_mul_lo_u32 v11, s11, v11
  v_add3_u32 v11, v10, v11, s10
  s_and_b32 s10, s73, 0xe0
  s_lshl_b32 s10, s10, 7
  s_add_u32 s10, s10, 14483456
  s_mov_b32 s11, 0
L_plg_3:
  buffer_load_dwordx2 v[8:9], v11, s[44:47], s10 offen sc1
  s_waitcnt vmcnt(0)
  v_cmp_eq_u64 vcc, s[14:15], v[8:9]
  v_cmp_eq_u64 s[8:9], s[74:75], v[8:9]
  s_mov_b32 s79, 1
  s_nop 0
  s_cmp_eq_u32 vcc_lo, -1
  s_cbranch_scc1 L_plg_3_ok
  s_mov_b32 s79, 0
  s_cmp_eq_u32 s9, -1
  s_cbranch_scc1 L_plg_3_ok
  s_add_u32 s11, s11, 1
  s_cmp_eq_u32 s11, 262144
  s_cbranch_scc1 L_plg_3_ok
  s_cmp_lg_u32 s11, 16
  s_cbranch_scc1 L_plg_3
  v_mov_b32 v24, 161760
L_aw_4:
  ds_read_b32 v25, v24
  s_waitcnt lgkmcnt(0)
  v_readfirstlane_b32 s6, v25
  s_nop 1
  s_cmp_ge_u32 s6, 4
  s_cbranch_scc1 L_aw_4_ok
  s_branch L_aw_4
L_aw_4_ok:
  s_lshr_b32 s6, s2, 3
  s_lshl_b32 s6, s6, 7
  s_sub_u32 s7, 16781184, s6
  s_add_u32 s6, s6, 19136512
  v_mov_b32 v24, v63
  s_mov_b32 s8, 0
L_rp_5:
  s_lshl_b32 s9, s8, 4
  v_xor_b32 v25, s9, v24
  ds_read_b128 v[16:19], v25
  ds_read_b128 v[20:23], v25 offset:8192
  s_waitcnt lgkmcnt(0)
  buffer_store_dwordx4 v[16:19], v65, s[44:47], s7 offen sc1
  buffer_store_dwordx4 v[20:23], v65, s[44:47], s6 offen sc1
  s_waitcnt vmcnt(0)
  v_add_u32 v24, 1024, v24
  s_add_u32 s6, s6, 34816
  s_add_u32 s7, s7, 34816
  s_add_u32 s8, s8, 1
  s_cmp_lt_u32 s8, 8
  s_cbranch_scc1 L_rp_5
  s_waitcnt vmcnt(0)
  v_mov_b32 v8, s74
  v_mov_b32 v9, s75
  v_mov_b32 v10, 0
  s_lshl_b32 s6, s73, 7
  s_add_u32 s6, s6, 14712832
  s_mov_b64 exec, 1
  buffer_store_dwordx2 v[8:9], v10, s[44:47], s6 offen sc1
  s_mov_b64 exec, -1
  s_branch L_plg_3
L_plg_3_ok:
  v_lshlrev_b32 v13, 4, v1
  s_mul_i32 s6, s73, 8704
  s_cmp_eq_u32 s79, 1
  s_cselect_b32 s7, 0, 16777216
  s_add_u32 s6, s6, s7
  s_mov_b32 m0, 117760
  s_add_u32 s7, s6, 0
  buffer_load_dwordx4 v13, s[44:47], s7 offen offset:0 sc1 lds
  buffer_load_dwordx4 v13, s[44:47], s7 offen offset:1024 sc1 lds
  buffer_load_dwordx4 v13, s[44:47], s7 offen offset:2048 sc1 lds
  buffer_load_dwordx4 v13, s[44:47], s7 offen offset:3072 sc1 lds
  s_mov_b32 m0, 122368
  s_add_u32 s7, s6, 4352
  buffer_load_dwordx4 v13, s[44:47], s7 offen offset:0 sc1 lds
  buffer_load_dwordx4 v13, s[44:47], s7 offen offset:1024 sc1 lds
  buffer_load_dwordx4 v13, s[44:47], s7 offen offset:2048 sc1 lds
  buffer_load_dwordx4 v13, s[44:47], s7 offen offset:3072 sc1 lds
  v_lshlrev_b32 v26, 4, v1
  v_and_b32 v27, 31, v1
  v_lshlrev_b32 v27, 7, v27
  s_and_b32 s10, s73, 0xe0
  s_lshl_b32 s10, s10, 7
  s_add_u32 s10, s10, 14680064
  s_mov_b32 s11, 14467072
  buffer_load_dwordx2 v[24:25], v27, s[44:47], s10 offen sc1
  buffer_load_dwordx2 v[16:17], v26, s[44:47], s11 offen offset:0 sc1
  buffer_load_dwordx2 v[18:19], v26, s[44:47], s11 offen offset:1024 sc1
  buffer_load_dwordx2 v[20:21], v26, s[44:47], s11 offen offset:2048 sc1
  buffer_load_dwordx2 v[22:23], v26, s[44:47], s11 offen offset:3072 sc1
  s_waitcnt vmcnt(5)
  v_mov_b32 v8, 161744
  v_mov_b32 v9, 1
  s_mov_b64 exec, 1
  ds_add_u32 v8, v9
  s_mov_b64 exec, -1
  s_mov_b32 s7, 262144
L_pxs_6:
  s_waitcnt vmcnt(0)
  v_cmp_eq_u64 vcc, s[14:15], v[24:25]
  s_cmp_eq_u32 s79, 1
  s_nop 0
  s_cselect_b64 vcc, vcc, exec
  v_cmp_eq_u64 s[8:9], s[74:75], v[16:17]
  s_nop 1
  s_and_b64 vcc, vcc, s[8:9]
  v_cmp_eq_u64 s[8:9], s[74:75], v[18:19]
  s_nop 1
  s_and_b64 vcc, vcc, s[8:9]
  v_cmp_eq_u64 s[8:9], s[74:75], v[20:21]
  s_nop 1
  s_and_b64 vcc, vcc, s[8:9]
  v_cmp_eq_u64 s[8:9], s[74:75], v[22:23]
  s_nop 1
  s_and_b64 vcc, vcc, s[8:9]
  s_cmp_eq_u64 vcc, exec
  s_cbranch_scc1 L_pxs_6_ok
  s_sub_u32 s7, s7, 1
  s_cmp_eq_u32 s7, 0
  s_cbranch_scc1 L_pxs_6_ok
  s_sleep 4
  buffer_load_dwordx2 v[24:25], v27, s[44:47], s10 offen sc1
  buffer_load_dwordx2 v[16:17], v26, s[44:47], s11 offen offset:0 sc1
  buffer_load_dwordx2 v[18:19], v26, s[44:47], s11 offen offset:1024 sc1
  buffer_load_dwordx2 v[20:21], v26, s[44:47], s11 offen offset:2048 sc1
  buffer_load_dwordx2 v[22:23], v26, s[44:47], s11 offen offset:3072 sc1
  s_branch L_pxs_6
L_pxs_6_ok:
  v_mov_b32 v8, 161760
L_aw_7:
  ds_read_b32 v9, v8
  s_waitcnt lgkmcnt(0)
  v_readfirstlane_b32 s6, v9
  s_nop 1
  s_cmp_ge_u32 s6, 4
  s_cbranch_scc1 L_aw_7_ok
  s_branch L_aw_7
L_aw_7_ok:
  v_lshlrev_b32 v13, 4, v1
  s_mul_i32 s6, s73, 8704
  s_cmp_eq_u32 s79, 1
  s_cselect_b32 s7, 0, 16777216
  s_add_u32 s6, s6, s7
  s_mov_b32 m0, 100352
  s_add_u32 s7, s6, 2359296
  buffer_load_dwordx4 v13, s[44:47], s7 offen offset:0 sc1 lds
  buffer_load_dwordx4 v13, s[44:47], s7 offen offset:1024 sc1 lds
  buffer_load_dwordx4 v13, s[44:47], s7 offen offset:2048 sc1 lds
  buffer_load_dwordx4 v13, s[44:47], s7 offen offset:3072 sc1 lds
  s_mov_b32 m0, 104448
  s_add_u32 s7, s6, 2363648
  buffer_load_dwordx4 v13, s[44:47], s7 offen offset:0 sc1 lds
  buffer_load_dwordx4 v13, s[44:47], s7 offen offset:1024 sc1 lds
  buffer_load_dwordx4 v13, s[44:47], s7 offen offset:2048 sc1 lds
  buffer_load_dwordx4 v13, s[44:47], s7 offen offset:3072 sc1 lds
  v_lshlrev_b32 v13, 4, v1
  s_mov_b32 m0, 126976
  s_mov_b32 s7, 14417920
  buffer_load_dwordx4 v13, s[44:47], s7 offen offset:0 sc1 lds
  buffer_load_dwordx4 v13, s[44:47], s7 offen offset:1024 sc1 lds
  buffer_load_dwordx4 v13, s[44:47], s7 offen offset:2048 sc1 lds
  buffer_load_dwordx4 v13, s[44:47], s7 offen offset:3072 sc1 lds
  s_mov_b32 m0, 131072
  s_mov_b32 s7, 14422016
  buffer_load_dwordx4 v13, s[44:47], s7 offen offset:0 sc1 lds
  buffer_load_dwordx4 v13, s[44:47], s7 offen offset:1024 sc1 lds
  buffer_load_dwordx4 v13, s[44:47], s7 offen offset:2048 sc1 lds
  buffer_load_dwordx4 v13, s[44:47], s7 offen offset:3072 sc1 lds
  s_mov_b32 m0, 135168
  s_mov_b32 s7, 14426112
  buffer_load_dwordx4 v13, s[44:47], s7 offen offset:0 sc1 lds
  buffer_load_dwordx4 v13, s[44:47], s7 offen offset:1024 sc1 lds
  buffer_load_dwordx4 v13, s[44:47], s7 offen offset:2048 sc1 lds
  buffer_load_dwordx4 v13, s[44:47], s7 offen offset:3072 sc1 lds
  s_mov_b32 m0, 139264
  s_mov_b32 s7, 14430208
  buffer_load_dwordx4 v13, s[44:47], s7 offen offset:0 sc1 lds
  buffer_load_dwordx4 v13, s[44:47], s7 offen offset:1024 sc1 lds
  buffer_load_dwordx4 v13, s[44:47], s7 offen offset:2048 sc1 lds
  buffer_load_dwordx4 v13, s[44:47], s7 offen offset:3072 sc1 lds
  s_waitcnt vmcnt(0)
  v_mov_b32 v8, 161732
  v_mov_b32 v9, 1
  s_mov_b64 exec, 1
  ds_add_u32 v8, v9
  s_mov_b64 exec, -1
  s_and_b32 s6, s2, 7
  s_lshr_b32 s7, s2, 3
  s_lshr_b32 s8, s6, 1
  s_lshl_b32 s8, s8, 2
  s_and_b32 s9, s7, 3
  s_add_u32 s76, s8, s9
  s_and_b32 s8, s6, 1
  s_lshl_b32 s8, s8, 3
  s_lshr_b32 s9, s7, 2
  s_add_u32 s77, s8, s9
  s_lshl_b32 s8, s76, 4
  s_add_u32 s78, s8, s77
  s_and_b32 s8, s76, 3
  s_lshl_b32 s8, s8, 2
  s_add_u32 s8, s8, s77
  s_and_b32 s5, s8, 15
  s_mov_b32 s48, s30
  s_mov_b32 s49, s31
  s_mov_b32 s50, 1835008
  s_mov_b32 s51, 0x00020000
  s_mov_b32 s52, s32
  s_mov_b32 s53, s33
  s_mov_b32 s54, 1835008
  s_mov_b32 s55, 0x00020000
  s_mov_b32 s80, -1
  s_mov_b32 s81, 0x00ffffff
  v_mul_u32_u24 v8, 4682, v1
  v_lshrrev_b32 v8, 16, v8
  v_mul_u32_u24 v9, 14, v8
  v_sub_u32 v9, v1, v9
  v_mul_u32_u24 v8, 3584, v8
  v_lshl_add_u32 v8, v9, 4, v8
  s_mul_i32 s6, s77, 224
  v_add_u32 v7, s6, v8
  s_mul_i32 s7, s3, 28672
  s_add_u32 s6, s6, s7
  v_add_u32 v2, s6, v8
  v_add_u32 v93, 14336, v2
  s_mul_i32 s6, s77, 114688
  s_mul_i32 s7, s3, 1792
  s_add_u32 s6, s6, s7
  s_add_u32 s6, s6, 22020096
  v_lshlrev_b32 v94, 4, v1
  v_add_u32 v94, s6, v94
  s_mul_i32 s83, s3, 1792
  s_lshl_b32 s84, s3, 11
  s_add_u32 s84, s84, 100352
  v_lshrrev_b32 v8, 4, v1
  v_and_b32 v9, 15, v1
  v_lshlrev_b32 v10, 1, v8
  v_xor_b32 v9, v9, v10
  v_xor_b32 v10, 8, v9
  v_mul_u32_u24 v11, 4352, v8
  s_mul_i32 s6, s3, 34816
  s_lshl_b32 s7, s76, 8
  s_add_u32 s6, s6, s7
  s_add_u32 s6, s6, 4718592
  v_add_u32 v11, s6, v11
  v_lshl_add_u32 v3, v9, 4, v11
  v_lshl_add_u32 v4, v10, 4, v11
  v_add_u32 v4, 17408, v4
  v_and_b32 v8, 31, v1
  s_lshl_b32 s6, s3, 5
  v_add_u32 v8, s6, v8
  v_lshlrev_b32 v6, 4, v8
  v_lshrrev_b32 v9, 5, v1
  v_lshl_add_u32 v5, v9, 14, v6
  v_add_u32 v6, 161792, v6
  v_lshlrev_b32 v97, 4, v1
  v_add_u32 v97, s84, v97
  s_mov_b32 s56, s34
  s_mov_b32 s57, s35
  s_mov_b32 s58, 1835008
  s_mov_b32 s59, 0x00020000
  v_lshrrev_b32 v8, 3, v1
  v_and_b32 v9, 7, v1
  v_bfe_u32 v10, v1, 4, 1
  v_lshlrev_b32 v10, 1, v10
  v_xor_b32 v10, v9, v10
  s_and_b32 s6, s3, 1
  s_lshl_b32 s6, s6, 2
  v_xor_b32 v10, s6, v10
  v_lshlrev_b32 v11, 10, v8
  v_lshl_add_u32 v11, v10, 4, v11
  s_and_b32 s7, s77, 7
  s_lshl_b32 s8, s7, 7
  s_lshl_b32 s9, s3, 13
  s_add_u32 s8, s8, s9
  v_add_u32 v90, s8, v11
  s_lshl_b32 s85, s3, 10
  v_lshlrev_b32 v91, 4, v1
  v_bfe_u32 v10, v1, 4, 2
  v_lshlrev_b32 v10, 1, v10
  v_xor_b32 v10, v9, v10
  v_mul_u32_u24 v11, 4352, v8
  v_lshl_add_u32 v11, v10, 4, v11
  s_lshl_b32 s8, s7, 6
  s_lshl_b32 s9, s3, 4
  s_add_u32 s8, s8, s9
  s_mul_i32 s8, s8, 4352
  s_lshr_b32 s9, s77, 3
  s_lshl_b32 s10, s76, 8
  s_add_u32 s8, s8, s10
  s_lshl_b32 s10, s9, 7
  s_add_u32 s8, s8, s10
  s_add_u32 s8, s8, 4718592
  v_add_u32 v92, s8, v11
  s_lshl_b32 s8, s76, 4
  s_lshr_b32 s10, s3, 1
  s_lshl_b32 s10, s10, 3
  s_add_u32 s8, s8, s10
  s_mul_i32 s8, s8, 28672
  s_mul_i32 s10, s9, 14336
  s_add_u32 s8, s8, s10
  s_and_b32 s10, s3, 1
  s_mul_i32 s10, s10, 7168
  s_add_u32 s8, s8, s10
  s_add_u32 s8, s8, 7077888
  s_mul_i32 s87, s3, 7168
  v_add_u32 v98, s87, v91
  s_and_b32 s10, s77, 0
  s_lshl_b32 s10, s10, 0
  s_add_u32 s10, s10, 0
  s_and_b32 s10, s10, 3
  s_mul_i32 s68, s10, 229376
  s_mul_i32 s10, s10, 57344
  s_add_u32 s60, s8, s10
  s_and_b32 s10, s77, 0
  s_lshl_b32 s10, s10, 0
  s_add_u32 s10, s10, 1
  s_and_b32 s10, s10, 3
  s_mul_i32 s69, s10, 229376
  s_mul_i32 s10, s10, 57344
  s_add_u32 s61, s8, s10
  s_and_b32 s10, s77, 0
  s_lshl_b32 s10, s10, 0
  s_add_u32 s10, s10, 2
  s_and_b32 s10, s10, 3
  s_mul_i32 s70, s10, 229376
  s_mul_i32 s10, s10, 57344
  s_add_u32 s62, s8, s10
  s_and_b32 s10, s77, 0
  s_lshl_b32 s10, s10, 0
  s_add_u32 s10, s10, 3
  s_and_b32 s10, s10, 3
  s_mul_i32 s71, s10, 229376
  s_mul_i32 s10, s10, 57344
  s_add_u32 s63, s8, s10
  s_branch L_s1_2
L_s1_2_x:
  v_mov_b32 v66, 161760
L_aw_8:
  ds_read_b32 v67, v66
  s_waitcnt lgkmcnt(0)
  v_readfirstlane_b32 s6, v67
  s_nop 1
  s_cmp_ge_u32 s6, 4
  s_cbranch_scc1 L_aw_8_ok
  s_branch L_aw_8
L_aw_8_ok:
  ds_read_b128 v[16:19], v63 offset:8192
  ds_read_b128 v[20:23], v64 offset:8192
  s_waitcnt lgkmcnt(1)
  buffer_store_dwordx4 v[16:19], v65, s[44:47], s12 offen
  s_waitcnt lgkmcnt(0)
  buffer_store_dwordx4 v[20:23], v65, s[44:47], s13 offen
  s_cmp_eq_u32 s3, 3
  s_cbranch_scc1 L_xs_9
  s_sub_u32 s6, s3, 1
  s_mul_i32 s7, s6, 4160
  s_add_u32 s7, s7, 108544
  v_lshlrev_b32 v24, 4, v1
  v_xor_b32 v24, s7, v24
  ds_read_b128 v[28:31], v24
  s_mul_i32 s7, s3, 34816
  v_subrev_u32 v25, s7, v65
  s_cmp_eq_u32 s3, 1
  s_cselect_b32 s7, s12, s13
  s_waitcnt lgkmcnt(0)
  buffer_store_dwordx4 v[28:31], v25, s[44:47], s7 offen
L_xs_9:
  s_and_b32 s6, s2, 7
  s_lshr_b32 s7, s2, 3
  s_lshr_b32 s8, s6, 1
  s_lshl_b32 s8, s8, 2
  s_and_b32 s9, s7, 3
  s_add_u32 s76, s8, s9
  s_and_b32 s8, s6, 1
  s_lshl_b32 s8, s8, 3
  s_lshr_b32 s9, s7, 2
  s_add_u32 s77, s8, s9
  s_lshl_b32 s8, s76, 4
  s_add_u32 s78, s8, s77
  s_and_b32 s8, s76, 3
  s_lshl_b32 s8, s8, 2
  s_add_u32 s8, s8, s77
  s_and_b32 s5, s8, 15
  s_mov_b32 s48, s30
  s_mov_b32 s49, s31
  s_mov_b32 s50, 1835008
  s_mov_b32 s51, 0x00020000
  s_mov_b32 s52, s32
  s_mov_b32 s53, s33
  s_mov_b32 s54, 1835008
  s_mov_b32 s55, 0x00020000
  s_mov_b32 s80, -1
  s_mov_b32 s81, 0x00ffffff
  v_mul_u32_u24 v8, 4682, v1
  v_lshrrev_b32 v8, 16, v8
  v_mul_u32_u24 v9, 14, v8
  v_sub_u32 v9, v1, v9
  v_mul_u32_u24 v8, 3584, v8
  v_lshl_add_u32 v8, v9, 4, v8
  s_mul_i32 s6, s77, 224
  v_add_u32 v7, s6, v8
  s_mul_i32 s7, s3, 28672
  s_add_u32 s6, s6, s7
  v_add_u32 v2, s6, v8
  v_add_u32 v93, 14336, v2
  s_mul_i32 s6, s77, 114688
  s_mul_i32 s7, s3, 1792
  s_add_u32 s6, s6, s7
  s_add_u32 s6, s6, 22020096
  v_lshlrev_b32 v94, 4, v1
  v_add_u32 v94, s6, v94
  s_mul_i32 s83, s3, 1792
  s_lshl_b32 s84, s3, 11
  s_add_u32 s84, s84, 100352
  v_lshrrev_b32 v8, 4, v1
  v_and_b32 v9, 15, v1
  v_lshlrev_b32 v10, 1, v8
  v_xor_b32 v9, v9, v10
  v_xor_b32 v10, 8, v9
  v_mul_u32_u24 v11, 4352, v8
  s_mul_i32 s6, s3, 34816
  s_lshl_b32 s7, s76, 8
  s_add_u32 s6, s6, s7
  s_add_u32 s6, s6, 4718592
  v_add_u32 v11, s6, v11
  v_lshl_add_u32 v3, v9, 4, v11
  v_lshl_add_u32 v4, v10, 4, v11
  v_add_u32 v4, 17408, v4
  v_and_b32 v8, 31, v1
  s_lshl_b32 s6, s3, 5
  v_add_u32 v8, s6, v8
  v_lshlrev_b32 v6, 4, v8
  v_lshrrev_b32 v9, 5, v1
  v_lshl_add_u32 v5, v9, 14, v6
  v_add_u32 v6, 161792, v6
  v_lshlrev_b32 v97, 4, v1
  v_add_u32 v97, s84, v97
  s_mov_b32 s56, s34
  s_mov_b32 s57, s35
  s_mov_b32 s58, 1835008
  s_mov_b32 s59, 0x00020000
  v_lshrrev_b32 v8, 3, v1
  v_and_b32 v9, 7, v1
  v_bfe_u32 v10, v1, 4, 1
  v_lshlrev_b32 v10, 1, v10
  v_xor_b32 v10, v9, v10
  s_and_b32 s6, s3, 1
  s_lshl_b32 s6, s6, 2
  v_xor_b32 v10, s6, v10
  v_lshlrev_b32 v11, 10, v8
  v_lshl_add_u32 v11, v10, 4, v11
  s_and_b32 s7, s77, 7
  s_lshl_b32 s8, s7, 7
  s_lshl_b32 s9, s3, 13
  s_add_u32 s8, s8, s9
  v_add_u32 v90, s8, v11
  s_lshl_b32 s85, s3, 10
  v_lshlrev_b32 v91, 4, v1
  v_bfe_u32 v10, v1, 4, 2
  v_lshlrev_b32 v10, 1, v10
  v_xor_b32 v10, v9, v10
  v_mul_u32_u24 v11, 4352, v8
  v_lshl_add_u32 v11, v10, 4, v11
  s_lshl_b32 s8, s7, 6
  s_lshl_b32 s9, s3, 4
  s_add_u32 s8, s8, s9
  s_mul_i32 s8, s8, 4352
  s_lshr_b32 s9, s77, 3
  s_lshl_b32 s10, s76, 8
  s_add_u32 s8, s8, s10
  s_lshl_b32 s10, s9, 7
  s_add_u32 s8, s8, s10
  s_add_u32 s8, s8, 4718592
  v_add_u32 v92, s8, v11
  s_lshl_b32 s8, s76, 4
  s_lshr_b32 s10, s3, 1
  s_lshl_b32 s10, s10, 3
  s_add_u32 s8, s8, s10
  s_mul_i32 s8, s8, 28672
  s_mul_i32 s10, s9, 14336
  s_add_u32 s8, s8, s10
  s_and_b32 s10, s3, 1
  s_mul_i32 s10, s10, 7168
  s_add_u32 s8, s8, s10
  s_add_u32 s8, s8, 7077888
  s_mul_i32 s87, s3, 7168
  v_add_u32 v98, s87, v91
  s_and_b32 s10, s77, 0
  s_lshl_b32 s10, s10, 0
  s_add_u32 s10, s10, 0
  s_and_b32 s10, s10, 3
  s_mul_i32 s68, s10, 229376
  s_mul_i32 s10, s10, 57344
  s_add_u32 s60, s8, s10
  s_and_b32 s10, s77, 0
  s_lshl_b32 s10, s10, 0
  s_add_u32 s10, s10, 1
  s_and_b32 s10, s10, 3
  s_mul_i32 s69, s10, 229376
  s_mul_i32 s10, s10, 57344
  s_add_u32 s61, s8, s10
  s_and_b32 s10, s77, 0
  s_lshl_b32 s10, s10, 0
  s_add_u32 s10, s10, 2
  s_and_b32 s10, s10, 3
  s_mul_i32 s70, s10, 229376
  s_mul_i32 s10, s10, 57344
  s_add_u32 s62, s8, s10
  s_and_b32 s10, s77, 0
  s_lshl_b32 s10, s10, 0
  s_add_u32 s10, s10, 3
  s_and_b32 s10, s10, 3
  s_mul_i32 s71, s10, 229376
  s_mul_i32 s10, s10, 57344
  s_add_u32 s63, s8, s10
  s_waitcnt vmcnt(0)
  v_mov_b32 v8, 161728
  v_mov_b32 v9, 1
  s_mov_b64 exec, 1
  ds_add_rtn_u32 v10, v8, v9
  s_mov_b64 exec, -1
  s_waitcnt lgkmcnt(0)
  v_readfirstlane_b32 s6, v10
  s_nop 1
  s_cmp_lg_u32 s6, 2
  s_cbranch_scc1 L_arr_10
  v_mov_b32 v8, s14
  v_mov_b32 v9, s15
  v_mov_b32 v10, 0
  s_lshl_b32 s6, s73, 7
  s_add_u32 s6, s6, 14680064
  s_mov_b64 exec, 1
  buffer_store_dwordx2 v[8:9], v10, s[44:47], s6 offen
  s_mov_b64 exec, -1
L_arr_10:
  s_mov_b64 exec, s[80:81]
  s_add_u32 s10, s5, 0
  s_and_b32 s10, s10, 15
  s_mul_i32 s8, s10, 114688
  s_add_u32 s9, s8, 14336
  s_add_u32 m0, s83, 0
  s_waitcnt vmcnt(4)
  buffer_load_dwordx4 v2, s[48:51], s8 offen lds
  s_add_u32 m0, s83, 896
  s_waitcnt vmcnt(4)
  buffer_load_dwordx4 v2, s[48:51], s9 offen lds
  s_add_u32 m0, s83, 7168
  s_waitcnt vmcnt(4)
  buffer_load_dwordx4 v2, s[52:55], s8 offen lds
  s_add_u32 m0, s83, 8064
  s_waitcnt vmcnt(4)
  buffer_load_dwordx4 v2, s[52:55], s9 offen lds
  s_mov_b64 exec, -1
  s_cmp_lg_u32 s3, 1
  s_cbranch_scc1 L_ow_11
  s_mov_b64 exec, s[80:81]
  s_add_u32 s10, s5, 0
  s_and_b32 s10, s10, 15
  s_mul_i32 s8, s10, 114688
  s_add_u32 s9, s8, 14336
  s_mov_b32 m0, 0
  s_waitcnt vmcnt(4)
  buffer_load_dwordx4 v7, s[48:51], s8 offen lds
  s_mov_b32 m0, 896
  s_waitcnt vmcnt(4)
  buffer_load_dwordx4 v7, s[48:51], s9 offen lds
  s_mov_b32 m0, 7168
  s_waitcnt vmcnt(4)
  buffer_load_dwordx4 v7, s[52:55], s8 offen lds
  s_mov_b32 m0, 8064
  s_waitcnt vmcnt(4)
  buffer_load_dwordx4 v7, s[52:55], s9 offen lds
  s_mov_b64 exec, -1
L_ow_11:
  s_mov_b64 exec, s[80:81]
  s_add_u32 s10, s5, 1
  s_and_b32 s10, s10, 15
  s_mul_i32 s8, s10, 114688
  s_add_u32 s9, s8, 14336
  s_add_u32 m0, s83, 14336
  s_waitcnt vmcnt(4)
  buffer_load_dwordx4 v2, s[48:51], s8 offen lds
  s_add_u32 m0, s83, 15232
  s_waitcnt vmcnt(4)
  buffer_load_dwordx4 v2, s[48:51], s9 offen lds
  s_add_u32 m0, s83, 21504
  s_waitcnt vmcnt(4)
  buffer_load_dwordx4 v2, s[52:55], s8 offen lds
  s_add_u32 m0, s83, 22400
  s_waitcnt vmcnt(4)
  buffer_load_dwordx4 v2, s[52:55], s9 offen lds
  s_mov_b64 exec, -1
  s_cmp_lg_u32 s3, 2
  s_cbranch_scc1 L_ow_12
  s_mov_b64 exec, s[80:81]
  s_add_u32 s10, s5, 1
  s_and_b32 s10, s10, 15
  s_mul_i32 s8, s10, 114688
  s_add_u32 s9, s8, 14336
  s_mov_b32 m0, 14336
  s_waitcnt vmcnt(4)
  buffer_load_dwordx4 v7, s[48:51], s8 offen lds
  s_mov_b32 m0, 15232
  s_waitcnt vmcnt(4)
  buffer_load_dwordx4 v7, s[48:51], s9 offen lds
  s_mov_b32 m0, 21504
  s_waitcnt vmcnt(4)
  buffer_load_dwordx4 v7, s[52:55], s8 offen lds
  s_mov_b32 m0, 22400
  s_waitcnt vmcnt(4)
  buffer_load_dwordx4 v7, s[52:55], s9 offen lds
  s_mov_b64 exec, -1
L_ow_12:
  s_mov_b64 exec, s[80:81]
  s_add_u32 s10, s5, 2
  s_and_b32 s10, s10, 15
  s_mul_i32 s8, s10, 114688
  s_add_u32 s9, s8, 14336
  s_add_u32 m0, s83, 28672
  s_waitcnt vmcnt(4)
  buffer_load_dwordx4 v2, s[48:51], s8 offen lds
  s_add_u32 m0, s83, 29568
  s_waitcnt vmcnt(4)
  buffer_load_dwordx4 v2, s[48:51], s9 offen lds
  s_add_u32 m0, s83, 35840
  s_waitcnt vmcnt(4)
  buffer_load_dwordx4 v2, s[52:55], s8 offen lds
  s_add_u32 m0, s83, 36736
  s_waitcnt vmcnt(4)
  buffer_load_dwordx4 v2, s[52:55], s9 offen lds
  s_mov_b64 exec, -1
  s_cmp_lg_u32 s3, 3
  s_cbranch_scc1 L_ow_13
  s_mov_b64 exec, s[80:81]
  s_add_u32 s10, s5, 2
  s_and_b32 s10, s10, 15
  s_mul_i32 s8, s10, 114688
  s_add_u32 s9, s8, 14336
  s_mov_b32 m0, 28672
  s_waitcnt vmcnt(4)
  buffer_load_dwordx4 v7, s[48:51], s8 offen lds
  s_mov_b32 m0, 29568
  s_waitcnt vmcnt(4)
  buffer_load_dwordx4 v7, s[48:51], s9 offen lds
  s_mov_b32 m0, 35840
  s_waitcnt vmcnt(4)
  buffer_load_dwordx4 v7, s[52:55], s8 offen lds
  s_mov_b32 m0, 36736
  s_waitcnt vmcnt(4)
  buffer_load_dwordx4 v7, s[52:55], s9 offen lds
  s_mov_b64 exec, -1
L_ow_13:
  s_cmp_lg_u32 s3, 2
  s_cbranch_scc1 L_ow_14
  v_mov_b32 v8, 161736
L_aw_15:
  ds_read_b32 v9, v8
  s_waitcnt lgkmcnt(0)
  v_readfirstlane_b32 s6, v9
  s_nop 1
  s_cmp_ge_u32 s6, 4
  s_cbranch_scc1 L_aw_15_ok
  s_branch L_aw_15
L_aw_15_ok:
  s_bfe_u32 s6, s2, 0x20001
  s_mul_i32 s6, s6, 28
  s_lshr_b32 s7, s2, 3
  s_add_u32 s6, s6, s7
  s_cmp_ge_u32 s6, 56
  s_cselect_b32 s8, 56, 0
  s_add_u32 s6, s6, s8
  s_and_b32 s8, s2, 1
  s_mul_i32 s8, s8, 56
  s_add_u32 s6, s6, s8
  s_cmp_lt_u32 s7, 28
  s_cselect_b32 s67, s6, 224
  v_lshlrev_b32 v9, 2, v1
  v_add_u32 v8, 160256, v9
  ds_read_b32 v48, v8 offset:0
  ds_read_b32 v49, v8 offset:256
  ds_read_b32 v50, v8 offset:512
  ds_read_b32 v51, v8 offset:768
  s_and_b32 s6, s67, 3
  s_mul_i32 s6, s6, 14336
  s_lshr_b32 s7, s67, 2
  s_lshl_b32 s7, s7, 8
  s_add_u32 s6, s6, s7
  s_add_u32 s6, s6, 14516224
  s_cmp_lt_u32 s67, 224
  s_cselect_b32 s6, s6, 26214400
  s_waitcnt lgkmcnt(0)
  v_add_f32 v48, v48, v50
  v_add_f32 v49, v49, v51
  v_add_f32 v48, v48, v49
  buffer_store_dword v48, v9, s[44:47], s6 offen sc1
L_ow_14:
  s_mov_b64 exec, s[80:81]
  s_add_u32 s10, s5, 3
  s_and_b32 s10, s10, 15
  s_mul_i32 s8, s10, 114688
  s_add_u32 s9, s8, 14336
  s_add_u32 m0, s83, 43008
  s_waitcnt vmcnt(4)
  buffer_load_dwordx4 v2, s[48:51], s8 offen lds
  s_add_u32 m0, s83, 43904
  s_waitcnt vmcnt(4)
  buffer_load_dwordx4 v2, s[48:51], s9 offen lds
  s_add_u32 m0, s83, 50176
  s_waitcnt vmcnt(4)
  buffer_load_dwordx4 v2, s[52:55], s8 offen lds
  s_add_u32 m0, s83, 51072
  s_waitcnt vmcnt(4)
  buffer_load_dwordx4 v2, s[52:55], s9 offen lds
  s_mov_b64 exec, -1
  s_cmp_lg_u32 s3, 1
  s_cbranch_scc1 L_ow_16
  s_mov_b64 exec, s[80:81]
  s_add_u32 s10, s5, 3
  s_and_b32 s10, s10, 15
  s_mul_i32 s8, s10, 114688
  s_add_u32 s9, s8, 14336
  s_mov_b32 m0, 43008
  s_waitcnt vmcnt(4)
  buffer_load_dwordx4 v7, s[48:51], s8 offen lds
  s_mov_b32 m0, 43904
  s_waitcnt vmcnt(4)
  buffer_load_dwordx4 v7, s[48:51], s9 offen lds
  s_mov_b32 m0, 50176
  s_waitcnt vmcnt(4)
  buffer_load_dwordx4 v7, s[52:55], s8 offen lds
  s_mov_b32 m0, 51072
  s_waitcnt vmcnt(4)
  buffer_load_dwordx4 v7, s[52:55], s9 offen lds
  s_mov_b64 exec, -1
L_ow_16:
  s_mov_b64 exec, s[80:81]
  s_add_u32 s10, s5, 4
  s_and_b32 s10, s10, 15
  s_mul_i32 s8, s10, 114688
  s_add_u32 s9, s8, 14336
  s_add_u32 m0, s83, 57344
  s_waitcnt vmcnt(4)
  buffer_load_dwordx4 v2, s[48:51], s8 offen lds
  s_add_u32 m0, s83, 58240
  s_waitcnt vmcnt(4)
  buffer_load_dwordx4 v2, s[48:51], s9 offen lds
  s_add_u32 m0, s83, 64512
  s_waitcnt vmcnt(4)
  buffer_load_dwordx4 v2, s[52:55], s8 offen lds
  s_add_u32 m0, s83, 65408
  s_waitcnt vmcnt(4)
  buffer_load_dwordx4 v2, s[52:55], s9 offen lds
  s_mov_b64 exec, -1
  s_cmp_lg_u32 s3, 2
  s_cbranch_scc1 L_ow_17
  s_mov_b64 exec, s[80:81]
  s_add_u32 s10, s5, 4
  s_and_b32 s10, s10, 15
  s_mul_i32 s8, s10, 114688
  s_add_u32 s9, s8, 14336
  s_mov_b32 m0, 57344
  s_waitcnt vmcnt(4)
  buffer_load_dwordx4 v7, s[48:51], s8 offen lds
  s_mov_b32 m0, 58240
  s_waitcnt vmcnt(4)
  buffer_load_dwordx4 v7, s[48:51], s9 offen lds
  s_mov_b32 m0, 64512
  s_waitcnt vmcnt(4)
  buffer_load_dwordx4 v7, s[52:55], s8 offen lds
  s_mov_b32 m0, 65408
  s_waitcnt vmcnt(4)
  buffer_load_dwordx4 v7, s[52:55], s9 offen lds
  s_mov_b64 exec, -1
L_ow_17:
  s_cmp_lg_u32 s3, 2
  s_cbranch_scc1 L_ow_18
  s_waitcnt vmcnt(8)
  v_mov_b32 v8, 161740
  v_mov_b32 v9, 1
  s_mov_b64 exec, 1
  ds_add_rtn_u32 v10, v8, v9
  s_mov_b64 exec, -1
  s_waitcnt lgkmcnt(0)
  v_readfirstlane_b32 s6, v10
  s_nop 1
  s_cmp_lg_u32 s6, 4
  s_cbranch_scc1 L_arr_19
  v_mov_b32 v8, s74
  v_mov_b32 v9, s75
  v_mov_b32 v10, 0
  s_lshl_b32 s6, s2, 4
  s_add_u32 s6, s6, 14458880
  s_mov_b64 exec, 1
  buffer_store_dwordx2 v[8:9], v10, s[44:47], s6 offen sc1
  s_mov_b64 exec, -1
L_arr_19:
L_ow_18:
  s_mov_b64 exec, s[80:81]
  s_add_u32 s10, s5, 5
  s_and_b32 s10, s10, 15
  s_mul_i32 s8, s10, 114688
  s_add_u32 s9, s8, 14336
  s_add_u32 m0, s83, 71680
  s_waitcnt vmcnt(4)
  buffer_load_dwordx4 v2, s[48:51], s8 offen lds
  s_add_u32 m0, s83, 72576
  s_waitcnt vmcnt(4)
  buffer_load_dwordx4 v2, s[48:51], s9 offen lds
  s_add_u32 m0, s83, 78848
  s_waitcnt vmcnt(4)
  buffer_load_dwordx4 v2, s[52:55], s8 offen lds
  s_add_u32 m0, s83, 79744
  s_waitcnt vmcnt(4)
  buffer_load_dwordx4 v2, s[52:55], s9 offen lds
  s_mov_b64 exec, -1
  s_cmp_lg_u32 s3, 3
  s_cbranch_scc1 L_ow_20
  s_mov_b64 exec, s[80:81]
  s_add_u32 s10, s5, 5
  s_and_b32 s10, s10, 15
  s_mul_i32 s8, s10, 114688
  s_add_u32 s9, s8, 14336
  s_mov_b32 m0, 71680
  s_waitcnt vmcnt(4)
  buffer_load_dwordx4 v7, s[48:51], s8 offen lds
  s_mov_b32 m0, 72576
  s_waitcnt vmcnt(4)
  buffer_load_dwordx4 v7, s[48:51], s9 offen lds
  s_mov_b32 m0, 78848
  s_waitcnt vmcnt(4)
  buffer_load_dwordx4 v7, s[52:55], s8 offen lds
  s_mov_b32 m0, 79744
  s_waitcnt vmcnt(4)
  buffer_load_dwordx4 v7, s[52:55], s9 offen lds
  s_mov_b64 exec, -1
L_ow_20:
  s_mov_b64 exec, s[80:81]
  s_add_u32 s10, s5, 6
  s_and_b32 s10, s10, 15
  s_mul_i32 s8, s10, 114688
  s_add_u32 s9, s8, 14336
  s_add_u32 m0, s83, 86016
  s_waitcnt vmcnt(4)
  buffer_load_dwordx4 v2, s[48:51], s8 offen lds
  s_add_u32 m0, s83, 86912
  s_waitcnt vmcnt(4)
  buffer_load_dwordx4 v2, s[48:51], s9 offen lds
  s_add_u32 m0, s83, 93184
  s_waitcnt vmcnt(4)
  buffer_load_dwordx4 v2, s[52:55], s8 offen lds
  s_add_u32 m0, s83, 94080
  s_waitcnt vmcnt(4)
  buffer_load_dwordx4 v2, s[52:55], s9 offen lds
  s_mov_b64 exec, -1
  s_cmp_lg_u32 s3, 1
  s_cbranch_scc1 L_ow_21
  s_mov_b64 exec, s[80:81]
  s_add_u32 s10, s5, 6
  s_and_b32 s10, s10, 15
  s_mul_i32 s8, s10, 114688
  s_add_u32 s9, s8, 14336
  s_mov_b32 m0, 86016
  s_waitcnt vmcnt(4)
  buffer_load_dwordx4 v7, s[48:51], s8 offen lds
  s_mov_b32 m0, 86912
  s_waitcnt vmcnt(4)
  buffer_load_dwordx4 v7, s[48:51], s9 offen lds
  s_mov_b32 m0, 93184
  s_waitcnt vmcnt(4)
  buffer_load_dwordx4 v7, s[52:55], s8 offen lds
  s_mov_b32 m0, 94080
  s_waitcnt vmcnt(4)
  buffer_load_dwordx4 v7, s[52:55], s9 offen lds
  s_mov_b64 exec, -1
L_ow_21:
  s_waitcnt vmcnt(0)
  v_mov_b32 v8, 161756
  v_mov_b32 v9, 1
  s_mov_b64 exec, 1
  ds_add_u32 v8, v9
  s_mov_b64 exec, -1
L_s1_2:
  v_mov_b32 v8, 161740
L_aw_22:
  ds_read_b32 v9, v8
  s_waitcnt lgkmcnt(0)
  v_readfirstlane_b32 s6, v9
  s_nop 1
  s_cmp_ge_u32 s6, 5
  s_cbranch_scc1 L_aw_22_ok
  s_sleep 1
  s_branch L_aw_22
L_aw_22_ok:
  s_sleep 12
  s_add_u32 s10, s5, 0
  s_and_b32 s10, s10, 15
  s_add_u32 m0, s84, 0
  s_mul_i32 s8, s10, 139264
  buffer_load_dwordx4 v3, s[44:47], s8 offen sc1 lds
  s_add_u32 m0, s84, 1024
  s_nop 0
  buffer_load_dwordx4 v4, s[44:47], s8 offen sc1 lds
  s_add_u32 s10, s5, 1
  s_and_b32 s10, s10, 15
  s_add_u32 m0, s84, 8192
  s_mul_i32 s8, s10, 139264
  buffer_load_dwordx4 v3, s[44:47], s8 offen sc1 lds
  s_add_u32 m0, s84, 9216
  s_nop 0
  buffer_load_dwordx4 v4, s[44:47], s8 offen sc1 lds
  s_add_u32 s10, s5, 2
  s_and_b32 s10, s10, 15
  s_add_u32 m0, s84, 16384
  s_mul_i32 s8, s10, 139264
  buffer_load_dwordx4 v3, s[44:47], s8 offen sc1 lds
  s_add_u32 m0, s84, 17408
  s_nop 0
  buffer_load_dwordx4 v4, s[44:47], s8 offen sc1 lds
  s_add_u32 s10, s5, 3
  s_and_b32 s10, s10, 15
  s_add_u32 m0, s84, 24576
  s_mul_i32 s8, s10, 139264
  buffer_load_dwordx4 v3, s[44:47], s8 offen sc1 lds
  s_add_u32 m0, s84, 25600
  s_nop 0
  buffer_load_dwordx4 v4, s[44:47], s8 offen sc1 lds
  s_mov_b32 s11, 48
  s_waitcnt vmcnt(4)
L_sp_23:
  ds_read_b32 v12, v97 offset:0
  ds_read_b32 v13, v97 offset:1024
  ds_read_b32 v14, v97 offset:8192
  ds_read_b32 v15, v97 offset:9216
  s_waitcnt lgkmcnt(0)
  v_max_u32 v12, v12, v13
  v_max_u32 v14, v14, v15
  v_max_u32 v12, v12, v14
  v_cmp_eq_u32 vcc, -1, v12
  s_nop 1
  s_cmp_eq_u64 vcc, 0
  s_cbranch_scc1 L_sp_23_ok
  s_cmp_eq_u32 s11, 0
  s_cbranch_scc1 L_sp_23_ok
  s_sub_u32 s11, s11, 1
  s_cmp_lg_u32 s11, 0
  s_cbranch_scc1 L_sp_23_go
  v_lshlrev_b32 v20, 4, v1
  s_mov_b32 s6, 14458880
  s_mov_b32 s7, 262144
L_poll_24:
  buffer_load_dwordx2 v[12:13], v20, s[44:47], s6 offen offset:0 sc1
  buffer_load_dwordx2 v[14:15], v20, s[44:47], s6 offen offset:1024 sc1
  buffer_load_dwordx2 v[16:17], v20, s[44:47], s6 offen offset:2048 sc1
  buffer_load_dwordx2 v[18:19], v20, s[44:47], s6 offen offset:3072 sc1
  s_waitcnt vmcnt(0)
  v_cmp_eq_u64 vcc, s[74:75], v[12:13]
  v_cmp_eq_u64 s[8:9], s[74:75], v[14:15]
  s_nop 1
  s_and_b64 vcc, vcc, s[8:9]
  v_cmp_eq_u64 s[8:9], s[74:75], v[16:17]
  s_nop 1
  s_and_b64 vcc, vcc, s[8:9]
  v_cmp_eq_u64 s[8:9], s[74:75], v[18:19]
  s_nop 1
  s_and_b64 vcc, vcc, s[8:9]
  s_nop 1
  s_cmp_eq_u64 vcc, exec
  s_cbranch_scc1 L_poll_24_ok
  s_sub_u32 s7, s7, 1
  s_cmp_eq_u32 s7, 0
  s_cbranch_scc1 L_poll_24_ok
  s_sleep 1
  s_branch L_poll_24
L_poll_24_ok:
L_sp_23_go:
  s_add_u32 s10, s5, 0
  s_and_b32 s10, s10, 15
  s_add_u32 m0, s84, 0
  s_mul_i32 s8, s10, 139264
  buffer_load_dwordx4 v3, s[44:47], s8 offen sc1 lds
  s_add_u32 m0, s84, 1024
  s_nop 0
  buffer_load_dwordx4 v4, s[44:47], s8 offen sc1 lds
  s_add_u32 s10, s5, 1
  s_and_b32 s10, s10, 15
  s_add_u32 m0, s84, 8192
  s_mul_i32 s8, s10, 139264
  buffer_load_dwordx4 v3, s[44:47], s8 offen sc1 lds
  s_add_u32 m0, s84, 9216
  s_nop 0
  buffer_load_dwordx4 v4, s[44:47], s8 offen sc1 lds
  s_waitcnt vmcnt(0)
  s_branch L_sp_23
L_sp_23_ok:
  s_barrier
  s_add_u32 s10, s5, 4
  s_and_b32 s10, s10, 15
  s_add_u32 m0, s84, 32768
  s_mul_i32 s8, s10, 139264
  buffer_load_dwordx4 v3, s[44:47], s8 offen sc1 lds
  s_add_u32 m0, s84, 33792
  s_nop 0
  buffer_load_dwordx4 v4, s[44:47], s8 offen sc1 lds
  s_add_u32 s10, s5, 5
  s_and_b32 s10, s10, 15
  s_add_u32 m0, s84, 40960
  s_mul_i32 s8, s10, 139264
  buffer_load_dwordx4 v3, s[44:47], s8 offen sc1 lds
  s_add_u32 m0, s84, 41984
  s_nop 0
  buffer_load_dwordx4 v4, s[44:47], s8 offen sc1 lds
  s_add_u32 s10, s5, 6
  s_and_b32 s10, s10, 15
  s_add_u32 m0, s84, 49152
  s_mul_i32 s8, s10, 139264
  buffer_load_dwordx4 v3, s[44:47], s8 offen sc1 lds
  s_add_u32 m0, s84, 50176
  s_nop 0
  buffer_load_dwordx4 v4, s[44:47], s8 offen sc1 lds
  s_mov_b32 s11, 48
  s_waitcnt vmcnt(6)
L_sp_25:
  ds_read_b32 v12, v97 offset:16384
  ds_read_b32 v13, v97 offset:17408
  ds_read_b32 v14, v97 offset:24576
  ds_read_b32 v15, v97 offset:25600
  s_waitcnt lgkmcnt(0)
  v_max_u32 v12, v12, v13
  v_max_u32 v14, v14, v15
  v_max_u32 v12, v12, v14
  v_cmp_eq_u32 vcc, -1, v12
  s_nop 1
  s_cmp_eq_u64 vcc, 0
  s_cbranch_scc1 L_sp_25_ok
  s_cmp_eq_u32 s11, 0
  s_cbranch_scc1 L_sp_25_ok
  s_sub_u32 s11, s11, 1
  s_cmp_lg_u32 s11, 0
  s_cbranch_scc1 L_sp_25_go
  v_lshlrev_b32 v20, 4, v1
  s_mov_b32 s6, 14458880
  s_mov_b32 s7, 262144
L_poll_26:
  buffer_load_dwordx2 v[12:13], v20, s[44:47], s6 offen offset:0 sc1
  buffer_load_dwordx2 v[14:15], v20, s[44:47], s6 offen offset:1024 sc1
  buffer_load_dwordx2 v[16:17], v20, s[44:47], s6 offen offset:2048 sc1
  buffer_load_dwordx2 v[18:19], v20, s[44:47], s6 offen offset:3072 sc1
  s_waitcnt vmcnt(0)
  v_cmp_eq_u64 vcc, s[74:75], v[12:13]
  v_cmp_eq_u64 s[8:9], s[74:75], v[14:15]
  s_nop 1
  s_and_b64 vcc, vcc, s[8:9]
  v_cmp_eq_u64 s[8:9], s[74:75], v[16:17]
  s_nop 1
  s_and_b64 vcc, vcc, s[8:9]
  v_cmp_eq_u64 s[8:9], s[74:75], v[18:19]
  s_nop 1
  s_and_b64 vcc, vcc, s[8:9]
  s_nop 1
  s_cmp_eq_u64 vcc, exec
  s_cbranch_scc1 L_poll_26_ok
  s_sub_u32 s7, s7, 1
  s_cmp_eq_u32 s7, 0
  s_cbranch_scc1 L_poll_26_ok
  s_sleep 1
  s_branch L_poll_26
L_poll_26_ok:
L_sp_25_go:
  s_add_u32 s10, s5, 2
  s_and_b32 s10, s10, 15
  s_add_u32 m0, s84, 16384
  s_mul_i32 s8, s10, 139264
  buffer_load_dwordx4 v3, s[44:47], s8 offen sc1 lds
  s_add_u32 m0, s84, 17408
  s_nop 0
  buffer_load_dwordx4 v4, s[44:47], s8 offen sc1 lds
  s_add_u32 s10, s5, 3
  s_and_b32 s10, s10, 15
  s_add_u32 m0, s84, 24576
  s_mul_i32 s8, s10, 139264
  buffer_load_dwordx4 v3, s[44:47], s8 offen sc1 lds
  s_add_u32 m0, s84, 25600
  s_nop 0
  buffer_load_dwordx4 v4, s[44:47], s8 offen sc1 lds
  s_waitcnt vmcnt(0)
  s_branch L_sp_25
L_sp_25_ok:
  s_barrier
  s_cmp_lg_u32 s3, 0
  s_cbranch_scc1 L_ow_27
  v_lshlrev_b32 v20, 4, v1
  s_mov_b32 s6, 14458880
  s_mov_b32 s7, 262144
L_poll_29:
  buffer_load_dwordx2 v[12:13], v20, s[44:47], s6 offen offset:0 sc1
  buffer_load_dwordx2 v[14:15], v20, s[44:47], s6 offen offset:1024 sc1
  buffer_load_dwordx2 v[16:17], v20, s[44:47], s6 offen offset:2048 sc1
  buffer_load_dwordx2 v[18:19], v20, s[44:47], s6 offen offset:3072 sc1
  s_waitcnt vmcnt(0)
  v_cmp_eq_u64 vcc, s[74:75], v[12:13]
  v_cmp_eq_u64 s[8:9], s[74:75], v[14:15]
  s_nop 1
  s_and_b64 vcc, vcc, s[8:9]
  v_cmp_eq_u64 s[8:9], s[74:75], v[16:17]
  s_nop 1
  s_and_b64 vcc, vcc, s[8:9]
  v_cmp_eq_u64 s[8:9], s[74:75], v[18:19]
  s_nop 1
  s_and_b64 vcc, vcc, s[8:9]
  s_nop 1
  s_cmp_eq_u64 vcc, exec
  s_cbranch_scc1 L_poll_29_ok
  s_sub_u32 s7, s7, 1
  s_cmp_eq_u32 s7, 0
  s_cbranch_scc1 L_poll_29_ok
  s_sleep 1
  s_branch L_poll_29
L_poll_29_ok:
  s_cmp_lg_u32 s2, 0
  s_cbranch_scc1 L_cf_28
  v_mov_b32 v8, s74
  v_mov_b32 v9, 14450688
  s_mov_b64 exec, 1
  buffer_store_dword v8, v9, s[44:47], 0 offen sc1
  s_mov_b64 exec, -1
L_cf_28:
L_ow_27:
  s_add_u32 s10, s5, 7
  s_and_b32 s10, s10, 15
  s_add_u32 m0, s84, 0
  s_mul_i32 s8, s10, 139264
  buffer_load_dwordx4 v3, s[44:47], s8 offen sc1 lds
  s_add_u32 m0, s84, 1024
  s_mul_i32 s9, s10, 114688
  buffer_load_dwordx4 v4, s[44:47], s8 offen sc1 lds
  s_add_u32 m0, s83, 0
  s_mov_b32 exec_hi, 0x00ffffff
  buffer_load_dwordx4 v2, s[48:51], s9 offen lds
  s_add_u32 m0, s83, 896
  s_nop 0
  buffer_load_dwordx4 v93, s[48:51], s9 offen lds
  s_add_u32 m0, s83, 7168
  s_nop 0
  buffer_load_dwordx4 v2, s[52:55], s9 offen lds
  s_add_u32 m0, s83, 8064
  s_nop 0
  buffer_load_dwordx4 v93, s[52:55], s9 offen lds
  s_mov_b32 exec_hi, -1
  s_add_u32 s10, s5, 8
  s_and_b32 s10, s10, 15
  s_add_u32 m0, s84, 8192
  s_mul_i32 s8, s10, 139264
  buffer_load_dwordx4 v3, s[44:47], s8 offen sc1 lds
  s_add_u32 m0, s84, 9216
  s_mul_i32 s9, s10, 114688
  buffer_load_dwordx4 v4, s[44:47], s8 offen sc1 lds
  s_add_u32 m0, s83, 14336
  s_mov_b32 exec_hi, 0x00ffffff
  buffer_load_dwordx4 v2, s[48:51], s9 offen lds
  s_add_u32 m0, s83, 15232
  s_nop 0
  buffer_load_dwordx4 v93, s[48:51], s9 offen lds
  s_add_u32 m0, s83, 21504
  s_nop 0
  buffer_load_dwordx4 v2, s[52:55], s9 offen lds
  s_add_u32 m0, s83, 22400
  s_nop 0
  buffer_load_dwordx4 v93, s[52:55], s9 offen lds
  s_mov_b32 exec_hi, -1
  s_mov_b32 s11, 48
  s_waitcnt vmcnt(14)
L_sp_30:
  ds_read_b32 v12, v97 offset:32768
  ds_read_b32 v13, v97 offset:33792
  ds_read_b32 v14, v97 offset:40960
  ds_read_b32 v15, v97 offset:41984
  s_waitcnt lgkmcnt(0)
  v_max_u32 v12, v12, v13
  v_max_u32 v14, v14, v15
  v_max_u32 v12, v12, v14
  v_cmp_eq_u32 vcc, -1, v12
  s_nop 1
  s_cmp_eq_u64 vcc, 0
  s_cbranch_scc1 L_sp_30_ok
  s_cmp_eq_u32 s11, 0
  s_cbranch_scc1 L_sp_30_ok
  s_sub_u32 s11, s11, 1
  s_cmp_lg_u32 s11, 0
  s_cbranch_scc1 L_sp_30_go
  v_lshlrev_b32 v20, 4, v1
  s_mov_b32 s6, 14458880
  s_mov_b32 s7, 262144
L_poll_31:
  buffer_load_dwordx2 v[12:13], v20, s[44:47], s6 offen offset:0 sc1
  buffer_load_dwordx2 v[14:15], v20, s[44:47], s6 offen offset:1024 sc1
  buffer_load_dwordx2 v[16:17], v20, s[44:47], s6 offen offset:2048 sc1
  buffer_load_dwordx2 v[18:19], v20, s[44:47], s6 offen offset:3072 sc1
  s_waitcnt vmcnt(0)
  v_cmp_eq_u64 vcc, s[74:75], v[12:13]
  v_cmp_eq_u64 s[8:9], s[74:75], v[14:15]
  s_nop 1
  s_and_b64 vcc, vcc, s[8:9]
  v_cmp_eq_u64 s[8:9], s[74:75], v[16:17]
  s_nop 1
  s_and_b64 vcc, vcc, s[8:9]
  v_cmp_eq_u64 s[8:9], s[74:75], v[18:19]
  s_nop 1
  s_and_b64 vcc, vcc, s[8:9]
  s_nop 1
  s_cmp_eq_u64 vcc, exec
  s_cbranch_scc1 L_poll_31_ok
  s_sub_u32 s7, s7, 1
  s_cmp_eq_u32 s7, 0
  s_cbranch_scc1 L_poll_31_ok
  s_sleep 1
  s_branch L_poll_31
L_poll_31_ok:
L_sp_30_go:
  s_add_u32 s10, s5, 4
  s_and_b32 s10, s10, 15
  s_add_u32 m0, s84, 32768
  s_mul_i32 s8, s10, 139264
  buffer_load_dwordx4 v3, s[44:47], s8 offen sc1 lds
  s_add_u32 m0, s84, 33792
  s_nop 0
  buffer_load_dwordx4 v4, s[44:47], s8 offen sc1 lds
  s_add_u32 s10, s5, 5
  s_and_b32 s10, s10, 15
  s_add_u32 m0, s84, 40960
  s_mul_i32 s8, s10, 139264
  buffer_load_dwordx4 v3, s[44:47], s8 offen sc1 lds
  s_add_u32 m0, s84, 41984
  s_nop 0
  buffer_load_dwordx4 v4, s[44:47], s8 offen sc1 lds
  s_waitcnt vmcnt(0)
  s_branch L_sp_30
L_sp_30_ok:
  s_barrier
  s_cmp_lg_u32 s3, 2
  s_cbranch_scc1 L_ow_32
  v_cmp_lt_u32 vcc, 27, v1
  v_mov_b32 v9, 6720
  s_mul_i32 s6, s77, 448
  v_cndmask_b32 v9, 0, v9, vcc
  v_lshl_add_u32 v8, v1, 4, v9
  s_add_u32 s6, s6, 14516224
  buffer_load_dwordx4 v[64:67], v8, s[44:47], s6 offen sc1
  s_add_u32 s6, s6, 14336
  buffer_load_dwordx4 v[68:71], v8, s[44:47], s6 offen sc1
  s_add_u32 s6, s6, 14336
  buffer_load_dwordx4 v[72:75], v8, s[44:47], s6 offen sc1
  s_add_u32 s6, s6, 14336
  buffer_load_dwordx4 v[76:79], v8, s[44:47], s6 offen sc1
L_ow_32:
  s_add_u32 s10, s5, 9
  s_and_b32 s10, s10, 15
  s_add_u32 m0, s84, 16384
  s_mul_i32 s8, s10, 139264
  buffer_load_dwordx4 v3, s[44:47], s8 offen sc1 lds
  s_add_u32 m0, s84, 17408
  s_mul_i32 s9, s10, 114688
  buffer_load_dwordx4 v4, s[44:47], s8 offen sc1 lds
  s_add_u32 m0, s83, 28672
  s_mov_b32 exec_hi, 0x00ffffff
  buffer_load_dwordx4 v2, s[48:51], s9 offen lds
  s_add_u32 m0, s83, 29568
  s_nop 0
  buffer_load_dwordx4 v93, s[48:51], s9 offen lds
  s_add_u32 m0, s83, 35840
  s_nop 0
  buffer_load_dwordx4 v2, s[52:55], s9 offen lds
  s_add_u32 m0, s83, 36736
  s_nop 0
  buffer_load_dwordx4 v93, s[52:55], s9 offen lds
  s_mov_b32 exec_hi, -1
  s_add_u32 s10, s5, 10
  s_and_b32 s10, s10, 15
  s_add_u32 m0, s84, 24576
  s_mul_i32 s8, s10, 139264
  buffer_load_dwordx4 v3, s[44:47], s8 offen sc1 lds
  s_add_u32 m0, s84, 25600
  s_mul_i32 s9, s10, 114688
  buffer_load_dwordx4 v4, s[44:47], s8 offen sc1 lds
  s_add_u32 m0, s83, 43008
  s_mov_b32 exec_hi, 0x00ffffff
  buffer_load_dwordx4 v2, s[48:51], s9 offen lds
  s_add_u32 m0, s83, 43904
  s_nop 0
  buffer_load_dwordx4 v93, s[48:51], s9 offen lds
  s_add_u32 m0, s83, 50176
  s_nop 0
  buffer_load_dwordx4 v2, s[52:55], s9 offen lds
  s_add_u32 m0, s83, 51072
  s_nop 0
  buffer_load_dwordx4 v93, s[52:55], s9 offen lds
  s_mov_b32 exec_hi, -1
  s_mov_b32 s11, 48
  s_waitcnt vmcnt(18)
L_sp_33:
  ds_read_b32 v12, v97 offset:49152
  ds_read_b32 v13, v97 offset:50176
  ds_read_b32 v14, v97 offset:0
  ds_read_b32 v15, v97 offset:1024
  s_waitcnt lgkmcnt(0)
  v_max_u32 v12, v12, v13
  v_max_u32 v14, v14, v15
  v_max_u32 v12, v12, v14
  v_cmp_eq_u32 vcc, -1, v12
  s_nop 1
  s_cmp_eq_u64 vcc, 0
  s_cbranch_scc1 L_sp_33_ok
  s_cmp_eq_u32 s11, 0
  s_cbranch_scc1 L_sp_33_ok
  s_sub_u32 s11, s11, 1
  s_cmp_lg_u32 s11, 0
  s_cbranch_scc1 L_sp_33_go
  v_lshlrev_b32 v20, 4, v1
  s_mov_b32 s6, 14458880
  s_mov_b32 s7, 262144
L_poll_34:
  buffer_load_dwordx2 v[12:13], v20, s[44:47], s6 offen offset:0 sc1
  buffer_load_dwordx2 v[14:15], v20, s[44:47], s6 offen offset:1024 sc1
  buffer_load_dwordx2 v[16:17], v20, s[44:47], s6 offen offset:2048 sc1
  buffer_load_dwordx2 v[18:19], v20, s[44:47], s6 offen offset:3072 sc1
  s_waitcnt vmcnt(0)
  v_cmp_eq_u64 vcc, s[74:75], v[12:13]
  v_cmp_eq_u64 s[8:9], s[74:75], v[14:15]
  s_nop 1
  s_and_b64 vcc, vcc, s[8:9]
  v_cmp_eq_u64 s[8:9], s[74:75], v[16:17]
  s_nop 1
  s_and_b64 vcc, vcc, s[8:9]
  v_cmp_eq_u64 s[8:9], s[74:75], v[18:19]
  s_nop 1
  s_and_b64 vcc, vcc, s[8:9]
  s_nop 1
  s_cmp_eq_u64 vcc, exec
  s_cbranch_scc1 L_poll_34_ok
  s_sub_u32 s7, s7, 1
  s_cmp_eq_u32 s7, 0
  s_cbranch_scc1 L_poll_34_ok
  s_sleep 1
  s_branch L_poll_34
L_poll_34_ok:
L_sp_33_go:
  s_add_u32 s10, s5, 6
  s_and_b32 s10, s10, 15
  s_add_u32 m0, s84, 49152
  s_mul_i32 s8, s10, 139264
  buffer_load_dwordx4 v3, s[44:47], s8 offen sc1 lds
  s_add_u32 m0, s84, 50176
  s_nop 0
  buffer_load_dwordx4 v4, s[44:47], s8 offen sc1 lds
  s_add_u32 s10, s5, 7
  s_and_b32 s10, s10, 15
  s_add_u32 m0, s84, 0
  s_mul_i32 s8, s10, 139264
  buffer_load_dwordx4 v3, s[44:47], s8 offen sc1 lds
  s_add_u32 m0, s84, 1024
  s_nop 0
  buffer_load_dwordx4 v4, s[44:47], s8 offen sc1 lds
  s_waitcnt vmcnt(0)
  s_branch L_sp_33
L_sp_33_ok:
  s_barrier
  s_add_u32 s10, s5, 11
  s_and_b32 s10, s10, 15
  s_add_u32 m0, s84, 32768
  s_mul_i32 s8, s10, 139264
  buffer_load_dwordx4 v3, s[44:47], s8 offen sc1 lds
  s_add_u32 m0, s84, 33792
  s_mul_i32 s9, s10, 114688
  buffer_load_dwordx4 v4, s[44:47], s8 offen sc1 lds
  s_add_u32 m0, s83, 57344
  s_mov_b32 exec_hi, 0x00ffffff
  buffer_load_dwordx4 v2, s[48:51], s9 offen lds
  s_add_u32 m0, s83, 58240
  s_nop 0
  buffer_load_dwordx4 v93, s[48:51], s9 offen lds
  s_add_u32 m0, s83, 64512
  s_nop 0
  buffer_load_dwordx4 v2, s[52:55], s9 offen lds
  s_add_u32 m0, s83, 65408
  s_nop 0
  buffer_load_dwordx4 v93, s[52:55], s9 offen lds
  s_mov_b32 exec_hi, -1
  s_add_u32 s10, s5, 12
  s_and_b32 s10, s10, 15
  s_add_u32 m0, s84, 40960
  s_mul_i32 s8, s10, 139264
  buffer_load_dwordx4 v3, s[44:47], s8 offen sc1 lds
  s_add_u32 m0, s84, 41984
  s_mul_i32 s9, s10, 114688
  buffer_load_dwordx4 v4, s[44:47], s8 offen sc1 lds
  s_add_u32 m0, s83, 71680
  s_mov_b32 exec_hi, 0x00ffffff
  buffer_load_dwordx4 v2, s[48:51], s9 offen lds
  s_add_u32 m0, s83, 72576
  s_nop 0
  buffer_load_dwordx4 v93, s[48:51], s9 offen lds
  s_add_u32 m0, s83, 78848
  s_nop 0
  buffer_load_dwordx4 v2, s[52:55], s9 offen lds
  s_add_u32 m0, s83, 79744
  s_nop 0
  buffer_load_dwordx4 v93, s[52:55], s9 offen lds
  s_mov_b32 exec_hi, -1
  s_mov_b32 s11, 48
  s_waitcnt vmcnt(18)
L_sp_35:
  ds_read_b32 v12, v97 offset:8192
  ds_read_b32 v13, v97 offset:9216
  ds_read_b32 v14, v97 offset:16384
  ds_read_b32 v15, v97 offset:17408
  s_waitcnt lgkmcnt(0)
  v_max_u32 v12, v12, v13
  v_max_u32 v14, v14, v15
  v_max_u32 v12, v12, v14
  v_cmp_eq_u32 vcc, -1, v12
  s_nop 1
  s_cmp_eq_u64 vcc, 0
  s_cbranch_scc1 L_sp_35_ok
  s_cmp_eq_u32 s11, 0
  s_cbranch_scc1 L_sp_35_ok
  s_sub_u32 s11, s11, 1
  s_cmp_lg_u32 s11, 0
  s_cbranch_scc1 L_sp_35_go
  v_lshlrev_b32 v20, 4, v1
  s_mov_b32 s6, 14458880
  s_mov_b32 s7, 262144
L_poll_36:
  buffer_load_dwordx2 v[12:13], v20, s[44:47], s6 offen offset:0 sc1
  buffer_load_dwordx2 v[14:15], v20, s[44:47], s6 offen offset:1024 sc1
  buffer_load_dwordx2 v[16:17], v20, s[44:47], s6 offen offset:2048 sc1
  buffer_load_dwordx2 v[18:19], v20, s[44:47], s6 offen offset:3072 sc1
  s_waitcnt vmcnt(0)
  v_cmp_eq_u64 vcc, s[74:75], v[12:13]
  v_cmp_eq_u64 s[8:9], s[74:75], v[14:15]
  s_nop 1
  s_and_b64 vcc, vcc, s[8:9]
  v_cmp_eq_u64 s[8:9], s[74:75], v[16:17]
  s_nop 1
  s_and_b64 vcc, vcc, s[8:9]
  v_cmp_eq_u64 s[8:9], s[74:75], v[18:19]
  s_nop 1
  s_and_b64 vcc, vcc, s[8:9]
  s_nop 1
  s_cmp_eq_u64 vcc, exec
  s_cbranch_scc1 L_poll_36_ok
  s_sub_u32 s7, s7, 1
  s_cmp_eq_u32 s7, 0
  s_cbranch_scc1 L_poll_36_ok
  s_sleep 1
  s_branch L_poll_36
L_poll_36_ok:
L_sp_35_go:
  s_add_u32 s10, s5, 8
  s_and_b32 s10, s10, 15
  s_add_u32 m0, s84, 8192
  s_mul_i32 s8, s10, 139264
  buffer_load_dwordx4 v3, s[44:47], s8 offen sc1 lds
  s_add_u32 m0, s84, 9216
  s_nop 0
  buffer_load_dwordx4 v4, s[44:47], s8 offen sc1 lds
  s_add_u32 s10, s5, 9
  s_and_b32 s10, s10, 15
  s_add_u32 m0, s84, 16384
  s_mul_i32 s8, s10, 139264
  buffer_load_dwordx4 v3, s[44:47], s8 offen sc1 lds
  s_add_u32 m0, s84, 17408
  s_nop 0
  buffer_load_dwordx4 v4, s[44:47], s8 offen sc1 lds
  s_waitcnt vmcnt(0)
  s_branch L_sp_35
L_sp_35_ok:
  s_barrier
  s_add_u32 s10, s5, 13
  s_and_b32 s10, s10, 15
  s_add_u32 m0, s84, 49152
  s_mul_i32 s8, s10, 139264
  buffer_load_dwordx4 v3, s[44:47], s8 offen sc1 lds
  s_add_u32 m0, s84, 50176
  s_mul_i32 s9, s10, 114688
  buffer_load_dwordx4 v4, s[44:47], s8 offen sc1 lds
  s_add_u32 m0, s83, 86016
  s_mov_b32 exec_hi, 0x00ffffff
  buffer_load_dwordx4 v2, s[48:51], s9 offen lds
  s_add_u32 m0, s83, 86912
  s_nop 0
  buffer_load_dwordx4 v93, s[48:51], s9 offen lds
  s_add_u32 m0, s83, 93184
  s_nop 0
  buffer_load_dwordx4 v2, s[52:55], s9 offen lds
  s_add_u32 m0, s83, 94080
  s_nop 0
  buffer_load_dwordx4 v93, s[52:55], s9 offen lds
  s_mov_b32 exec_hi, -1
  s_add_u32 s10, s5, 14
  s_and_b32 s10, s10, 15
  s_add_u32 m0, s84, 0
  s_mul_i32 s8, s10, 139264
  buffer_load_dwordx4 v3, s[44:47], s8 offen sc1 lds
  s_add_u32 m0, s84, 1024
  s_mul_i32 s9, s10, 114688
  buffer_load_dwordx4 v4, s[44:47], s8 offen sc1 lds
  s_add_u32 m0, s83, 0
  s_mov_b32 exec_hi, 0x00ffffff
  buffer_load_dwordx4 v2, s[48:51], s9 offen lds
  s_add_u32 m0, s83, 896
  s_nop 0
  buffer_load_dwordx4 v93, s[48:51], s9 offen lds
  s_add_u32 m0, s83, 7168
  s_nop 0
  buffer_load_dwordx4 v2, s[52:55], s9 offen lds
  s_add_u32 m0, s83, 8064
  s_nop 0
  buffer_load_dwordx4 v93, s[52:55], s9 offen lds
  s_mov_b32 exec_hi, -1
  s_waitcnt vmcnt(18)
  s_barrier
  s_add_u32 s10, s5, 15
  s_and_b32 s10, s10, 15
  s_add_u32 m0, s84, 8192
  s_mul_i32 s8, s10, 139264
  buffer_load_dwordx4 v3, s[44:47], s8 offen sc1 lds
  s_add_u32 m0, s84, 9216
  s_mul_i32 s9, s10, 114688
  buffer_load_dwordx4 v4, s[44:47], s8 offen sc1 lds
  s_add_u32 m0, s83, 14336
  s_mov_b32 exec_hi, 0x00ffffff
  buffer_load_dwordx4 v2, s[48:51], s9 offen lds
  s_add_u32 m0, s83, 15232
  s_nop 0
  buffer_load_dwordx4 v93, s[48:51], s9 offen lds
  s_add_u32 m0, s83, 21504
  s_nop 0
  buffer_load_dwordx4 v2, s[52:55], s9 offen lds
  s_add_u32 m0, s83, 22400
  s_nop 0
  buffer_load_dwordx4 v93, s[52:55], s9 offen lds
  s_mov_b32 exec_hi, -1
  s_lshl_b32 s6, s76, 15
  s_add_u32 s6, s6, 14745600
  buffer_load_dwordx4 v[32:35], v5, s[44:47], s6 offen offset:0 sc1
  buffer_load_dwordx4 v[36:39], v5, s[44:47], s6 offen offset:2048 sc1
  s_add_u32 s6, s6, 4096
  buffer_load_dwordx4 v[40:43], v5, s[44:47], s6 offen offset:0 sc1
  buffer_load_dwordx4 v[44:47], v5, s[44:47], s6 offen offset:2048 sc1
  s_add_u32 s6, s6, 4096
  buffer_load_dwordx4 v[48:51], v5, s[44:47], s6 offen offset:0 sc1
  buffer_load_dwordx4 v[52:55], v5, s[44:47], s6 offen offset:2048 sc1
  s_add_u32 s6, s6, 4096
  buffer_load_dwordx4 v[56:59], v5, s[44:47], s6 offen offset:0 sc1
  buffer_load_dwordx4 v[60:63], v5, s[44:47], s6 offen offset:2048 sc1
  s_add_u32 m0, s85, 32768
  s_add_u32 s8, s68, 131072
  buffer_load_dwordx4 v90, s[56:59], s8 offen lds
  s_add_u32 m0, s85, 36864
  s_add_u32 s8, s68, 1048576
  buffer_load_dwordx4 v90, s[56:59], s8 offen lds
  s_waitcnt vmcnt(22)
  s_barrier
  s_waitcnt vmcnt(2)
  s_mov_b32 s7, 262144
L_rec_37:
  v_cmp_eq_u64 vcc, s[74:75], v[34:35]
  v_cmp_eq_u64 s[10:11], s[74:75], v[38:39]
  v_cmp_eq_u64 s[8:9], s[74:75], v[42:43]
  s_and_b64 vcc, vcc, s[10:11]
  v_cmp_eq_u64 s[10:11], s[74:75], v[46:47]
  s_and_b64 vcc, vcc, s[8:9]
  v_cmp_eq_u64 s[8:9], s[74:75], v[50:51]
  s_and_b64 vcc, vcc, s[10:11]
  v_cmp_eq_u64 s[10:11], s[74:75], v[54:55]
  s_and_b64 vcc, vcc, s[8:9]
  v_cmp_eq_u64 s[8:9], s[74:75], v[58:59]
  s_and_b64 vcc, vcc, s[10:11]
  v_cmp_eq_u64 s[10:11], s[74:75], v[62:63]
  s_and_b64 vcc, vcc, s[8:9]
  s_nop 1
  s_and_b64 vcc, vcc, s[10:11]
  s_cmp_eq_u64 vcc, exec
  s_cbranch_scc1 L_rec_37_ok
  s_sub_u32 s7, s7, 1
  s_cmp_eq_u32 s7, 0
  s_cbranch_scc1 L_rec_37_ok
  s_sleep 1
  s_lshl_b32 s6, s76, 15
  s_add_u32 s6, s6, 14745600
  buffer_load_dwordx4 v[32:35], v5, s[44:47], s6 offen offset:0 sc1
  buffer_load_dwordx4 v[36:39], v5, s[44:47], s6 offen offset:2048 sc1
  s_add_u32 s6, s6, 4096
  buffer_load_dwordx4 v[40:43], v5, s[44:47], s6 offen offset:0 sc1
  buffer_load_dwordx4 v[44:47], v5, s[44:47], s6 offen offset:2048 sc1
  s_add_u32 s6, s6, 4096
  buffer_load_dwordx4 v[48:51], v5, s[44:47], s6 offen offset:0 sc1
  buffer_load_dwordx4 v[52:55], v5, s[44:47], s6 offen offset:2048 sc1
  s_add_u32 s6, s6, 4096
  buffer_load_dwordx4 v[56:59], v5, s[44:47], s6 offen offset:0 sc1
  buffer_load_dwordx4 v[60:63], v5, s[44:47], s6 offen offset:2048 sc1
  s_waitcnt vmcnt(0)
  s_branch L_rec_37
L_rec_37_ok:
  s_add_u32 m0, s85, 40960
  s_add_u32 s8, s68, 163840
  buffer_load_dwordx4 v90, s[56:59], s8 offen lds
  s_add_u32 m0, s85, 45056
  s_add_u32 s8, s68, 1081344
  buffer_load_dwordx4 v90, s[56:59], s8 offen lds
  s_add_u32 m0, s85, 49152
  s_add_u32 s8, s68, 196608
  buffer_load_dwordx4 v90, s[56:59], s8 offen lds
  s_add_u32 m0, s85, 53248
  s_add_u32 s8, s68, 1114112
  buffer_load_dwordx4 v90, s[56:59], s8 offen lds
  s_add_u32 m0, s85, 57344
  s_add_u32 s8, s69, 0
  buffer_load_dwordx4 v90, s[56:59], s8 offen lds
  s_add_u32 m0, s85, 61440
  s_add_u32 s8, s69, 917504
  buffer_load_dwordx4 v90, s[56:59], s8 offen lds
  s_add_u32 m0, s85, 122880
  s_add_u32 s8, s71, 65536
  buffer_load_dwordx4 v90, s[56:59], s8 offen lds
  s_add_u32 m0, s85, 126976
  s_add_u32 s8, s71, 983040
  buffer_load_dwordx4 v90, s[56:59], s8 offen lds
  s_add_u32 m0, s85, 131072
  s_add_u32 s8, s71, 98304
  buffer_load_dwordx4 v90, s[56:59], s8 offen lds
  s_add_u32 m0, s85, 135168
  s_add_u32 s8, s71, 1015808
  buffer_load_dwordx4 v90, s[56:59], s8 offen lds
  s_barrier
  v_add_f32 v32, v32, v36
  v_add_f32 v33, v33, v37
  v_add_f32 v40, v40, v44
  v_add_f32 v41, v41, v45
  v_add_f32 v48, v48, v52
  v_add_f32 v49, v49, v53
  v_add_f32 v56, v56, v60
  v_add_f32 v57, v57, v61
  v_add_f32 v32, v32, v40
  v_add_f32 v33, v33, v41
  v_add_f32 v48, v48, v56
  v_add_f32 v49, v49, v57
  v_add_f32 v32, v32, v48
  v_add_f32 v33, v33, v49
  v_mov_b32 v36, v32
  v_mov_b32 v37, v33
  s_nop 1
  v_permlane32_swap_b32 v32, v36
  v_permlane32_swap_b32 v33, v37
  s_nop 1
  v_add_f32 v32, v32, v36
  v_add_f32 v33, v33, v37
  v_mul_f32 v40, 0xbb000000, v32
  v_mul_f32 v33, 0x3b000000, v33
  v_fma_f32 v33, -v40, v40, v33
  v_max_f32 v33, 0, v33
  v_add_f32 v42, 0x3727c5ac, v33
  v_rsq_f32 v43, v42
  s_nop 0
  v_mul_f32 v41, 0xbfb8aa3b, v43
  ds_write_b128 v6, v[40:43]
  s_waitcnt lgkmcnt(0)
  s_cmp_lg_u32 s3, 2
  s_cbranch_scc1 L_ow_38
  v_add_f32 v64, v64, v68
  v_add_f32 v72, v72, v76
  v_add_f32 v65, v65, v69
  v_add_f32 v73, v73, v77
  v_add_f32 v66, v66, v70
  v_add_f32 v74, v74, v78
  v_add_f32 v67, v67, v71
  v_add_f32 v75, v75, v79
  v_lshlrev_b32 v8, 4, v1
  v_add_u32 v8, 158208, v8
  v_add_f32 v64, v64, v72
  v_add_f32 v65, v65, v73
  v_add_f32 v66, v66, v74
  v_add_f32 v67, v67, v75
  ds_write_b128 v8, v[64:67]
  s_waitcnt lgkmcnt(0)
L_ow_38:
  s_add_u32 m0, s85, 65536
  s_add_u32 s8, s69, 32768
  buffer_load_dwordx4 v90, s[56:59], s8 offen lds
  s_add_u32 m0, s85, 69632
  s_add_u32 s8, s69, 950272
  buffer_load_dwordx4 v90, s[56:59], s8 offen lds
  s_add_u32 m0, s85, 73728
  s_add_u32 s8, s69, 65536
  buffer_load_dwordx4 v90, s[56:59], s8 offen lds
  s_add_u32 m0, s85, 77824
  s_add_u32 s8, s69, 983040
  buffer_load_dwordx4 v90, s[56:59], s8 offen lds
  s_add_u32 m0, s85, 81920
  s_add_u32 s8, s69, 98304
  buffer_load_dwordx4 v90, s[56:59], s8 offen lds
  s_add_u32 m0, s85, 86016
  s_add_u32 s8, s69, 1015808
  buffer_load_dwordx4 v90, s[56:59], s8 offen lds
  s_add_u32 m0, s85, 90112
  s_add_u32 s8, s69, 131072
  buffer_load_dwordx4 v90, s[56:59], s8 offen lds
  s_add_u32 m0, s85, 94208
  s_add_u32 s8, s69, 1048576
  buffer_load_dwordx4 v90, s[56:59], s8 offen lds
  s_add_u32 m0, s85, 139264
  s_add_u32 s8, s71, 131072
  buffer_load_dwordx4 v90, s[56:59], s8 offen lds
  s_add_u32 m0, s85, 143360
  s_add_u32 s8, s71, 1048576
  buffer_load_dwordx4 v90, s[56:59], s8 offen lds
  s_add_u32 m0, s85, 147456
  s_add_u32 s8, s71, 163840
  buffer_load_dwordx4 v90, s[56:59], s8 offen lds
  s_add_u32 m0, s85, 151552
  s_add_u32 s8, s71, 1081344
  buffer_load_dwordx4 v90, s[56:59], s8 offen lds
  s_barrier
  s_add_u32 m0, s85, 0
  s_add_u32 s8, s68, 0
  buffer_load_dwordx4 v90, s[56:59], s8 offen lds
  s_add_u32 m0, s85, 4096
  s_add_u32 s8, s68, 917504
  buffer_load_dwordx4 v90, s[56:59], s8 offen lds
  s_add_u32 m0, s85, 8192
  s_add_u32 s8, s68, 32768
  buffer_load_dwordx4 v90, s[56:59], s8 offen lds
  s_add_u32 m0, s85, 12288
  s_add_u32 s8, s68, 950272
  buffer_load_dwordx4 v90, s[56:59], s8 offen lds
  s_add_u32 m0, s85, 16384
  s_add_u32 s8, s68, 65536
  buffer_load_dwordx4 v90, s[56:59], s8 offen lds
  s_add_u32 m0, s85, 20480
  s_add_u32 s8, s68, 983040
  buffer_load_dwordx4 v90, s[56:59], s8 offen lds
  s_add_u32 m0, s85, 24576
  s_add_u32 s8, s68, 98304
  buffer_load_dwordx4 v90, s[56:59], s8 offen lds
  s_add_u32 m0, s85, 28672
  s_add_u32 s8, s68, 1015808
  buffer_load_dwordx4 v90, s[56:59], s8 offen lds
  s_add_u32 m0, s85, 98304
  s_add_u32 s8, s69, 163840
  buffer_load_dwordx4 v90, s[56:59], s8 offen lds
  s_add_u32 m0, s85, 102400
  s_add_u32 s8, s69, 1081344
  buffer_load_dwordx4 v90, s[56:59], s8 offen lds
  s_add_u32 m0, s85, 106496
  s_add_u32 s8, s69, 196608
  buffer_load_dwordx4 v90, s[56:59], s8 offen lds
  s_add_u32 m0, s85, 110592
  s_add_u32 s8, s69, 1114112
  buffer_load_dwordx4 v90, s[56:59], s8 offen lds
  s_add_u32 m0, s85, 114688
  s_add_u32 s8, s71, 32768
  buffer_load_dwordx4 v90, s[56:59], s8 offen lds
  s_add_u32 m0, s85, 118784
  s_add_u32 s8, s71, 950272
  buffer_load_dwordx4 v90, s[56:59], s8 offen lds
  s_waitcnt vmcnt(0)
  s_barrier
  s_barrier
  s_add_u32 m0, s85, 49152
  s_add_u32 s8, s70, 0
  buffer_load_dwordx4 v90, s[56:59], s8 offen lds
  s_add_u32 m0, s85, 53248
  s_add_u32 s8, s70, 917504
  buffer_load_dwordx4 v90, s[56:59], s8 offen lds
  s_add_u32 m0, s85, 57344
  s_add_u32 s8, s70, 32768
  buffer_load_dwordx4 v90, s[56:59], s8 offen lds
  s_add_u32 m0, s85, 61440
  s_add_u32 s8, s70, 950272
  buffer_load_dwordx4 v90, s[56:59], s8 offen lds
  s_add_u32 m0, s85, 65536
  s_add_u32 s8, s70, 65536
  buffer_load_dwordx4 v90, s[56:59], s8 offen lds
  s_add_u32 m0, s85, 69632
  s_add_u32 s8, s70, 983040
  buffer_load_dwordx4 v90, s[56:59], s8 offen lds
  s_add_u32 m0, s85, 73728
  s_add_u32 s8, s70, 98304
  buffer_load_dwordx4 v90, s[56:59], s8 offen lds
  s_add_u32 m0, s85, 77824
  s_add_u32 s8, s70, 1015808
  buffer_load_dwordx4 v90, s[56:59], s8 offen lds
  s_add_u32 m0, s85, 81920
  s_add_u32 s8, s70, 131072
  buffer_load_dwordx4 v90, s[56:59], s8 offen lds
  s_add_u32 m0, s85, 86016
  s_add_u32 s8, s70, 1048576
  buffer_load_dwordx4 v90, s[56:59], s8 offen lds
  s_add_u32 m0, s85, 90112
  s_add_u32 s8, s70, 163840
  buffer_load_dwordx4 v90, s[56:59], s8 offen lds
  s_add_u32 m0, s85, 94208
  s_add_u32 s8, s70, 1081344
  buffer_load_dwordx4 v90, s[56:59], s8 offen lds
  s_add_u32 m0, s85, 98304
  s_add_u32 s8, s70, 196608
  buffer_load_dwordx4 v90, s[56:59], s8 offen lds
  s_add_u32 m0, s85, 102400
  s_add_u32 s8, s70, 1114112
  buffer_load_dwordx4 v90, s[56:59], s8 offen lds
  s_add_u32 m0, s85, 106496
  s_add_u32 s8, s71, 0
  buffer_load_dwordx4 v90, s[56:59], s8 offen lds
  s_add_u32 m0, s85, 110592
  s_add_u32 s8, s71, 917504
  buffer_load_dwordx4 v90, s[56:59], s8 offen lds
  s_add_u32 m0, s85, 155648
  s_add_u32 s8, s71, 196608
  buffer_load_dwordx4 v90, s[56:59], s8 offen lds
  s_add_u32 m0, s85, 159744
  s_add_u32 s8, s71, 1114112
  buffer_load_dwordx4 v90, s[56:59], s8 offen lds
  s_waitcnt vmcnt(0)
  s_barrier
  s_cmp_lg_u32 s3, 0
  s_cbranch_scc1 L_ow_39
  s_lshl_b32 s10, s76, 4
  v_and_b32 v16, 15, v1
  v_lshlrev_b32 v16, 4, v16
  s_lshl_b32 s6, s10, 4
  s_add_u32 s6, s6, 14462976
  s_mov_b32 s7, 262144
L_poll_40:
  buffer_load_dwordx2 v[8:9], v16, s[44:47], s6 offen offset:0 sc1
  s_waitcnt vmcnt(0)
  v_cmp_eq_u64 vcc, s[74:75], v[8:9]
  s_nop 1
  s_cmp_eq_u64 vcc, exec
  s_cbranch_scc1 L_poll_40_ok
  s_sub_u32 s7, s7, 1
  s_cmp_eq_u32 s7, 0
  s_cbranch_scc1 L_poll_40_ok
  s_sleep 1
  s_branch L_poll_40
L_poll_40_ok:
L_ow_39:
  s_barrier
  s_add_u32 m0, s87, 0
  s_add_u32 s8, s60, 0
  buffer_load_dwordx4 v91, s[44:47], s8 offen offset:0 sc1 lds
  buffer_load_dwordx4 v91, s[44:47], s8 offen offset:1024 sc1 lds
  buffer_load_dwordx4 v91, s[44:47], s8 offen offset:2048 sc1 lds
  buffer_load_dwordx4 v91, s[44:47], s8 offen offset:3072 sc1 lds
  s_add_u32 m0, s87, 4096
  s_add_u32 s8, s60, 4096
  buffer_load_dwordx4 v91, s[44:47], s8 offen offset:0 sc1 lds
  buffer_load_dwordx4 v91, s[44:47], s8 offen offset:1024 sc1 lds
  buffer_load_dwordx4 v91, s[44:47], s8 offen offset:2048 sc1 lds
  s_add_u32 m0, s87, 28672
  s_add_u32 s8, s60, 28672
  buffer_load_dwordx4 v91, s[44:47], s8 offen offset:0 sc1 lds
  buffer_load_dwordx4 v91, s[44:47], s8 offen offset:1024 sc1 lds
  buffer_load_dwordx4 v91, s[44:47], s8 offen offset:2048 sc1 lds
  buffer_load_dwordx4 v91, s[44:47], s8 offen offset:3072 sc1 lds
  s_add_u32 m0, s87, 32768
  s_add_u32 s8, s60, 32768
  buffer_load_dwordx4 v91, s[44:47], s8 offen offset:0 sc1 lds
  buffer_load_dwordx4 v91, s[44:47], s8 offen offset:1024 sc1 lds
  buffer_load_dwordx4 v91, s[44:47], s8 offen offset:2048 sc1 lds
  s_waitcnt vmcnt(7)
  s_barrier
  s_add_u32 m0, s87, 57344
  s_add_u32 s8, s61, 0
  buffer_load_dwordx4 v91, s[44:47], s8 offen offset:0 sc1 lds
  buffer_load_dwordx4 v91, s[44:47], s8 offen offset:1024 sc1 lds
  buffer_load_dwordx4 v91, s[44:47], s8 offen offset:2048 sc1 lds
  buffer_load_dwordx4 v91, s[44:47], s8 offen offset:3072 sc1 lds
  s_add_u32 m0, s87, 61440
  s_add_u32 s8, s61, 4096
  buffer_load_dwordx4 v91, s[44:47], s8 offen offset:0 sc1 lds
  buffer_load_dwordx4 v91, s[44:47], s8 offen offset:1024 sc1 lds
  buffer_load_dwordx4 v91, s[44:47], s8 offen offset:2048 sc1 lds
  s_waitcnt vmcnt(7)
  s_barrier
  s_add_u32 m0, s87, 86016
  s_add_u32 s8, s61, 28672
  buffer_load_dwordx4 v91, s[44:47], s8 offen offset:0 sc1 lds
  buffer_load_dwordx4 v91, s[44:47], s8 offen offset:1024 sc1 lds
  buffer_load_dwordx4 v91, s[44:47], s8 offen offset:2048 sc1 lds
  buffer_load_dwordx4 v91, s[44:47], s8 offen offset:3072 sc1 lds
  s_add_u32 m0, s87, 90112
  s_add_u32 s8, s61, 32768
  buffer_load_dwordx4 v91, s[44:47], s8 offen offset:0 sc1 lds
  buffer_load_dwordx4 v91, s[44:47], s8 offen offset:1024 sc1 lds
  buffer_load_dwordx4 v91, s[44:47], s8 offen offset:2048 sc1 lds
  s_waitcnt vmcnt(7)
  s_barrier
  s_add_u32 m0, s87, 0
  s_add_u32 s8, s62, 0
  buffer_load_dwordx4 v91, s[44:47], s8 offen offset:0 sc1 lds
  buffer_load_dwordx4 v91, s[44:47], s8 offen offset:1024 sc1 lds
  buffer_load_dwordx4 v91, s[44:47], s8 offen offset:2048 sc1 lds
  buffer_load_dwordx4 v91, s[44:47], s8 offen offset:3072 sc1 lds
  s_add_u32 m0, s87, 4096
  s_add_u32 s8, s62, 4096
  buffer_load_dwordx4 v91, s[44:47], s8 offen offset:0 sc1 lds
  buffer_load_dwordx4 v91, s[44:47], s8 offen offset:1024 sc1 lds
  buffer_load_dwordx4 v91, s[44:47], s8 offen offset:2048 sc1 lds
  s_waitcnt vmcnt(7)
  s_barrier
  s_add_u32 m0, s87, 28672
  s_add_u32 s8, s62, 28672
  buffer_load_dwordx4 v91, s[44:47], s8 offen offset:0 sc1 lds
  buffer_load_dwordx4 v91, s[44:47], s8 offen offset:1024 sc1 lds
  buffer_load_dwordx4 v91, s[44:47], s8 offen offset:2048 sc1 lds
  buffer_load_dwordx4 v91, s[44:47], s8 offen offset:3072 sc1 lds
  s_add_u32 m0, s87, 32768
  s_add_u32 s8, s62, 32768
  buffer_load_dwordx4 v91, s[44:47], s8 offen offset:0 sc1 lds
  buffer_load_dwordx4 v91, s[44:47], s8 offen offset:1024 sc1 lds
  buffer_load_dwordx4 v91, s[44:47], s8 offen offset:2048 sc1 lds
  s_waitcnt vmcnt(7)
  s_barrier
  s_add_u32 m0, s87, 57344
  s_add_u32 s8, s63, 0
  buffer_load_dwordx4 v91, s[44:47], s8 offen offset:0 sc1 lds
  buffer_load_dwordx4 v91, s[44:47], s8 offen offset:1024 sc1 lds
  buffer_load_dwordx4 v91, s[44:47], s8 offen offset:2048 sc1 lds
  buffer_load_dwordx4 v91, s[44:47], s8 offen offset:3072 sc1 lds
  s_add_u32 m0, s87, 61440
  s_add_u32 s8, s63, 4096
  buffer_load_dwordx4 v91, s[44:47], s8 offen offset:0 sc1 lds
  buffer_load_dwordx4 v91, s[44:47], s8 offen offset:1024 sc1 lds
  buffer_load_dwordx4 v91, s[44:47], s8 offen offset:2048 sc1 lds
  s_waitcnt vmcnt(7)
  s_barrier
  s_add_u32 m0, s87, 86016
  s_add_u32 s8, s63, 28672
  buffer_load_dwordx4 v91, s[44:47], s8 offen offset:0 sc1 lds
  buffer_load_dwordx4 v91, s[44:47], s8 offen offset:1024 sc1 lds
  buffer_load_dwordx4 v91, s[44:47], s8 offen offset:2048 sc1 lds
  buffer_load_dwordx4 v91, s[44:47], s8 offen offset:3072 sc1 lds
  s_add_u32 m0, s87, 90112
  s_add_u32 s8, s63, 32768
  buffer_load_dwordx4 v91, s[44:47], s8 offen offset:0 sc1 lds
  buffer_load_dwordx4 v91, s[44:47], s8 offen offset:1024 sc1 lds
  buffer_load_dwordx4 v91, s[44:47], s8 offen offset:2048 sc1 lds
  s_lshl_b32 s9, s3, 11
  s_add_u32 m0, s9, 114688
  s_nop 0
  buffer_load_dwordx4 v92, s[44:47], 0 offen sc1 lds
  s_add_u32 m0, s9, 115712
  s_mov_b32 s8, 34816
  buffer_load_dwordx4 v92, s[44:47], s8 offen sc1 lds
  s_waitcnt vmcnt(9)
  s_barrier
  s_waitcnt vmcnt(0)
  s_barrier
  s_barrier
  s_branch L_end
L_roleM:
  s_sub_u32 s4, s3, 4
  v_and_b32 v1, 63, v0
  v_mov_b32 v13, 161728
  v_mov_b32 v14, 0
  v_mov_b32 v15, 0
  ds_write_b64 v13, v[14:15] offset:0
  ds_write_b64 v13, v[14:15] offset:8
  ds_write_b64 v13, v[14:15] offset:16
  ds_write_b64 v13, v[14:15] offset:24
  ds_write_b64 v13, v[14:15] offset:32
  ds_write_b64 v13, v[14:15] offset:40
  ds_write_b64 v13, v[14:15] offset:48
  s_cmp_lg_u32 s3, 7
  s_cbranch_scc1 L_ow_41
  s_lshr_b32 s6, s2, 3
  s_cmp_ge_u32 s6, (L_end-L_begin+8191)/8192
  s_cbranch_scc1 L_tc_42
  s_getpc_b64 s[52:53]
L_tc_42_pc:
  s_sub_u32 s52, s52, L_tc_42_pc-L_begin
  s_subb_u32 s53, s53, 0
  s_mov_b32 s54, L_end-L_begin
  s_mov_b32 s55, 0x00020000
  s_lshl_b32 s6, s6, 13
  v_lshlrev_b32 v13, 7, v1
  buffer_load_dword v10, v13, s[52:55], s6 offen
L_tc_42:
L_ow_41:
  s_waitcnt lgkmcnt(0)
  s_barrier
  s_mov_b32 s56, s16
  s_mov_b32 s57, s17
  s_mov_b32 s58, 2097152
  s_mov_b32 s59, 0x00020000
  s_lshl_b32 s5, s2, 3
  s_lshl_b32 s6, s4, 1
  s_add_u32 s5, s5, s6
  v_lshrrev_b32 v2, 5, v1
  v_add_u32 v2, s5, v2
  v_and_b32 v3, 31, v1
  v_lshlrev_b32 v3, 5, v3
  v_lshl_add_u32 v3, v2, 10, v3
  buffer_load_dwordx4 v[16:19], v3, s[56:59], 0 offen nt
  buffer_load_dwordx4 v[20:23], v3, s[56:59], 0 offen offset:16 nt
  v_lshlrev_b32 v4, 3, v2
  v_add_u32 v4, 14417920, v4
  s_lshr_b32 s68, s4, 1
  s_lshl_b32 s6, s73, 1
  s_add_u32 s69, s6, s68
  s_lshl_b32 s7, s73, 2
  s_load_dword s71, s[26:27], s7
  s_and_b32 s70, s4, 1
  s_mov_b32 s48, s24
  s_mov_b32 s49, s25
  s_mov_b32 s50, 2097152
  s_mov_b32 s51, 0x00020000
  s_lshl_b32 s6, s69, 12
  s_lshl_b32 s7, s70, 1
  s_add_u32 s7, s7, s6
  s_mul_i32 s8, s4, 4160
  s_add_u32 s8, s8, 143360
  s_add_u32 m0, s8, 32
  v_lshlrev_b32 v13, 4, v1
  v_mov_b32 v14, 0
  buffer_load_dwordx4 v13, s[48:51], s7 offen offset:0 nt lds
  buffer_load_dwordx4 v13, s[48:51], s7 offen offset:1024 nt lds
  buffer_load_dwordx4 v13, s[48:51], s7 offen offset:2048 nt lds
  buffer_load_dwordx4 v13, s[48:51], s7 offen offset:3072 nt lds
  buffer_load_ushort v44, v14, s[48:51], s6 offen nt
  v_and_b32 v11, 15, v1
  v_lshrrev_b32 v12, 4, v1
  v_lshl_add_u32 v13, v12, 3, v11
  v_add_u32 v13, 1, v13
  v_and_b32 v15, 1, v13
  v_mul_u32_u24 v15, 4160, v15
  v_and_b32 v13, -2, v13
  v_lshl_add_u32 v13, v13, 1, v15
  s_mul_i32 s6, s68, 8320
  s_lshl_b32 s7, s70, 8
  s_add_u32 s6, s6, s7
  s_add_u32 s6, s6, 143360
  v_add_u32 v7, s6, v13
  v_lshlrev_b32 v45, 2, v1
  v_add_u32 v45, s8, v45
  s_mul_i32 s6, s68, 4608
  s_add_u32 s6, s6, 117760
  v_lshlrev_b32 v13, 4, v12
  v_lshlrev_b32 v14, 5, v11
  v_sub_u32 v13, v13, v14
  s_lshl_b32 s7, s70, 8
  s_add_u32 s7, s7, s6
  s_add_u32 s7, s7, 480
  v_add_u32 v9, s7, v13
  v_lshlrev_b32 v13, 3, v1
  v_add_u32 v13, s6, v13
  v_mov_b32 v14, 0
  v_mov_b32 v15, 0
  ds_write_b64 v13, v[14:15] offset:4096
  s_lshl_b32 s6, s73, 1
  s_lshr_b32 s7, s4, 1
  s_add_u32 s6, s6, s7
  s_mul_i32 s6, s6, 4352
  s_and_b32 s7, s4, 1
  s_lshl_b32 s7, s7, 11
  s_add_u32 s6, s6, s7
  s_add_u32 s6, s6, 4718592
  v_lshlrev_b32 v46, 4, v1
  v_mov_b32 v48, -1
  v_mov_b32 v49, -1
  v_mov_b32 v50, -1
  v_mov_b32 v51, -1
  buffer_store_dwordx4 v[48:51], v46, s[44:47], s6 offen sc1
  buffer_store_dwordx4 v[48:51], v46, s[44:47], s6 offen offset:1024 sc1
  s_mul_i32 s74, s74, 0x9E3779B1
  s_add_u32 s74, s74, 0x7F4A7C15
  s_not_b32 s75, s74
  s_getreg_b32 s15, hwreg(HW_REG_XCC_ID, 0, 4)
  s_mov_b32 s14, s74
  s_add_u32 s15, s15, 1
  s_sub_u32 s15, s75, s15
  s_waitcnt vmcnt(7)
  v_lshlrev_b32 v24, 16, v16
  v_and_b32 v25, s64, v16
  v_lshlrev_b32 v26, 16, v17
  v_and_b32 v27, s64, v17
  v_lshlrev_b32 v28, 16, v18
  v_and_b32 v29, s64, v18
  v_lshlrev_b32 v30, 16, v19
  v_and_b32 v31, s64, v19
  v_lshlrev_b32 v32, 16, v20
  v_and_b32 v33, s64, v20
  v_lshlrev_b32 v34, 16, v21
  v_and_b32 v35, s64, v21
  v_lshlrev_b32 v36, 16, v22
  v_and_b32 v37, s64, v22
  v_lshlrev_b32 v38, 16, v23
  v_and_b32 v39, s64, v23
  v_pk_mul_f32 v[42:43], v[24:25], v[24:25]
  v_pk_add_f32 v[40:41], v[24:25], v[26:27]
  v_pk_fma_f32 v[42:43], v[26:27], v[26:27], v[42:43]
  v_pk_add_f32 v[40:41], v[40:41], v[28:29]
  v_pk_fma_f32 v[42:43], v[28:29], v[28:29], v[42:43]
  v_pk_add_f32 v[40:41], v[40:41], v[30:31]
  v_pk_fma_f32 v[42:43], v[30:31], v[30:31], v[42:43]
  v_pk_add_f32 v[40:41], v[40:41], v[32:33]
  v_pk_fma_f32 v[42:43], v[32:33], v[32:33], v[42:43]
  v_pk_add_f32 v[40:41], v[40:41], v[34:35]
  v_pk_fma_f32 v[42:43], v[34:35], v[34:35], v[42:43]
  v_pk_add_f32 v[40:41], v[40:41], v[36:37]
  v_pk_fma_f32 v[42:43], v[36:37], v[36:37], v[42:43]
  v_pk_add_f32 v[40:41], v[40:41], v[38:39]
  v_pk_fma_f32 v[42:43], v[38:39], v[38:39], v[42:43]
  v_add_f32 v40, v40, v41
  v_add_f32 v41, v42, v43
  s_nop 1
  v_add_f32_dpp v40, v40, v40 quad_perm:[1,0,3,2] row_mask:0xf bank_mask:0xf
  v_add_f32_dpp v41, v41, v41 quad_perm:[1,0,3,2] row_mask:0xf bank_mask:0xf
  s_nop 1
  v_add_f32_dpp v40, v40, v40 quad_perm:[2,3,0,1] row_mask:0xf bank_mask:0xf
  v_add_f32_dpp v41, v41, v41 quad_perm:[2,3,0,1] row_mask:0xf bank_mask:0xf
  s_nop 1
  v_add_f32_dpp v40, v40, v40 row_half_mirror row_mask:0xf bank_mask:0xf
  v_add_f32_dpp v41, v41, v41 row_half_mirror row_mask:0xf bank_mask:0xf
  s_nop 1
  v_add_f32_dpp v40, v40, v40 row_mirror row_mask:0xf bank_mask:0xf
  v_add_f32_dpp v41, v41, v41 row_mirror row_mask:0xf bank_mask:0xf
  s_nop 1
  v_add_f32_dpp v40, v40, v40 row_bcast:15 row_mask:0xa bank_mask:0xf
  v_add_f32_dpp v41, v41, v41 row_bcast:15 row_mask:0xa bank_mask:0xf
  v_mul_f32 v40, 0x3b000000, v40
  v_mul_f32 v41, 0x3b000000, v41
  v_fma_f32 v41, -v40, v40, v41
  v_max_f32 v41, 0, v41
  v_add_f32 v41, 0x3727c5ac, v41
  v_rsq_f32 v41, v41
  s_mov_b32 s6, 0x00010000
  s_mov_b32 s7, 0x00010000
  s_mov_b64 exec, s[6:7]
  buffer_store_dwordx2 v[40:41], v4, s[44:47], 0 offen sc1
  s_mov_b64 exec, -1
  s_bfe_u32 s6, s2, 0x20001
  s_mul_i32 s6, s6, 28
  s_lshr_b32 s7, s2, 3
  s_add_u32 s6, s6, s7
  s_cmp_ge_u32 s6, 56
  s_cselect_b32 s8, 56, 0
  s_add_u32 s6, s6, s8
  s_and_b32 s8, s2, 1
  s_mul_i32 s8, s8, 56
  s_add_u32 s6, s6, s8
  s_cmp_lt_u32 s7, 28
  s_cselect_b32 s67, s6, 224
  s_lshr_b32 s8, s67, 2
  s_cmp_lt_u32 s8, 28
  s_cselect_b32 s60, s30, s32
  s_cselect_b32 s61, s31, s33
  s_cselect_b32 s6, 0, 28
  s_sub_u32 s6, s8, s6
  s_cmp_lt_u32 s67, 224
  s_cselect_b32 s62, 1835008, 0
  s_mov_b32 s63, 0x00020000
  s_lshl_b32 s6, s6, 7
  s_and_b32 s7, s67, 3
  s_lshl_b32 s7, s7, 2
  s_add_u32 s7, s7, s4
  s_mul_i32 s7, s7, 114688
  s_add_u32 s6, s6, s7
  v_lshrrev_b32 v5, 3, v1
  v_mul_u32_u24 v5, 3584, v5
  v_and_b32 v6, 7, v1
  v_lshl_add_u32 v5, v6, 4, v5
  s_add_u32 s7, s6, 28672
  s_add_u32 s8, s6, 57344
  s_add_u32 s9, s6, 86016
  buffer_load_dwordx4 v[48:51], v5, s[60:63], s6 offen
  buffer_load_dwordx4 v[52:55], v5, s[60:63], s7 offen
  buffer_load_dwordx4 v[56:59], v5, s[60:63], s8 offen
  buffer_load_dwordx4 v[60:63], v5, s[60:63], s9 offen
  s_waitcnt vmcnt(4)
  v_mov_b32 v16, 161752
  v_mov_b32 v17, 1
  s_mov_b64 exec, 1
  ds_add_rtn_u32 v18, v16, v17
  s_mov_b64 exec, -1
  s_waitcnt lgkmcnt(0)
  v_readfirstlane_b32 s6, v18
  s_nop 1
  s_cmp_lg_u32 s6, 3
  s_cbranch_scc1 L_arr_43
  v_mov_b32 v16, s74
  v_mov_b32 v17, s75
  v_mov_b32 v18, 0
  s_lshl_b32 s6, s2, 4
  s_add_u32 s6, s6, 14467072
  s_mov_b64 exec, 1
  buffer_store_dwordx2 v[16:17], v18, s[44:47], s6 offen sc1
  s_mov_b64 exec, -1
L_arr_43:
  v_lshlrev_b32 v44, 16, v44
  v_mul_lo_u32 v44, v44, s70
  v_cmp_eq_u32 vcc, 7, v1
  s_nop 1
  v_cndmask_b32 v44, 0, v44, vcc
  s_mov_b64 exec, 0xff
  ds_write_b32 v45, v44
  s_mov_b64 exec, -1
  s_waitcnt lgkmcnt(0)
  v_mov_b32 v16, 161764
  v_mov_b32 v17, 1
  s_mov_b64 exec, 1
  ds_add_u32 v16, v17
  s_mov_b64 exec, -1
  v_mov_b32 v16, 161764
L_aw_44:
  ds_read_b32 v17, v16
  s_waitcnt lgkmcnt(0)
  v_readfirstlane_b32 s6, v17
  s_nop 1
  s_cmp_ge_u32 s6, 4
  s_cbranch_scc1 L_aw_44_ok
  s_branch L_aw_44
L_aw_44_ok:
  v_add_u32 v97, 1024, v7
  v_add_u32 v98, 2048, v7
  v_add_u32 v99, 3072, v7
  ds_read2_b32 v[128:129], v7 offset0:0 offset1:1
  ds_read2_b32 v[130:131], v7 offset0:2 offset1:3
  ds_read2_b32 v[132:133], v7 offset0:128 offset1:129
  ds_read2_b32 v[134:135], v7 offset0:130 offset1:131
  ds_read2_b32 v[136:137], v97 offset0:0 offset1:1
  ds_read2_b32 v[138:139], v97 offset0:2 offset1:3
  ds_read2_b32 v[140:141], v97 offset0:128 offset1:129
  ds_read2_b32 v[142:143], v97 offset0:130 offset1:131
  ds_read2_b32 v[144:145], v98 offset0:0 offset1:1
  ds_read2_b32 v[146:147], v98 offset0:2 offset1:3
  ds_read2_b32 v[148:149], v98 offset0:128 offset1:129
  ds_read2_b32 v[150:151], v98 offset0:130 offset1:131
  ds_read2_b32 v[152:153], v99 offset0:0 offset1:1
  ds_read2_b32 v[154:155], v99 offset0:2 offset1:3
  ds_read2_b32 v[156:157], v99 offset0:128 offset1:129
  ds_read2_b32 v[158:159], v99 offset0:130 offset1:131
  ds_read2_b32 v[160:161], v7 offset0:16 offset1:17
  ds_read2_b32 v[162:163], v7 offset0:18 offset1:19
  ds_read2_b32 v[164:165], v7 offset0:144 offset1:145
  ds_read2_b32 v[166:167], v7 offset0:146 offset1:147
  ds_read2_b32 v[168:169], v97 offset0:16 offset1:17
  ds_read2_b32 v[170:171], v97 offset0:18 offset1:19
  ds_read2_b32 v[172:173], v97 offset0:144 offset1:145
  ds_read2_b32 v[174:175], v97 offset0:146 offset1:147
  ds_read2_b32 v[176:177], v98 offset0:16 offset1:17
  ds_read2_b32 v[178:179], v98 offset0:18 offset1:19
  ds_read2_b32 v[180:181], v98 offset0:144 offset1:145
  ds_read2_b32 v[182:183], v98 offset0:146 offset1:147
  ds_read2_b32 v[184:185], v99 offset0:16 offset1:17
  ds_read2_b32 v[186:187], v99 offset0:18 offset1:19
  ds_read2_b32 v[188:189], v99 offset0:144 offset1:145
  ds_read2_b32 v[190:191], v99 offset0:146 offset1:147
  ds_read2_b32 v[192:193], v7 offset0:32 offset1:33
  ds_read2_b32 v[194:195], v7 offset0:34 offset1:35
  ds_read2_b32 v[196:197], v7 offset0:160 offset1:161
  ds_read2_b32 v[198:199], v7 offset0:162 offset1:163
  ds_read2_b32 v[200:201], v97 offset0:32 offset1:33
  ds_read2_b32 v[202:203], v97 offset0:34 offset1:35
  ds_read2_b32 v[204:205], v97 offset0:160 offset1:161
  ds_read2_b32 v[206:207], v97 offset0:162 offset1:163
  ds_read2_b32 v[208:209], v98 offset0:32 offset1:33
  ds_read2_b32 v[210:211], v98 offset0:34 offset1:35
  ds_read2_b32 v[212:213], v98 offset0:160 offset1:161
  ds_read2_b32 v[214:215], v98 offset0:162 offset1:163
  ds_read2_b32 v[216:217], v99 offset0:32 offset1:33
  ds_read2_b32 v[218:219], v99 offset0:34 offset1:35
  ds_read2_b32 v[220:221], v99 offset0:160 offset1:161
  ds_read2_b32 v[222:223], v99 offset0:162 offset1:163
  ds_read2_b32 v[224:225], v7 offset0:48 offset1:49
  ds_read2_b32 v[226:227], v7 offset0:50 offset1:51
  ds_read2_b32 v[228:229], v7 offset0:176 offset1:177
  ds_read2_b32 v[230:231], v7 offset0:178 offset1:179
  ds_read2_b32 v[232:233], v97 offset0:48 offset1:49
  ds_read2_b32 v[234:235], v97 offset0:50 offset1:51
  ds_read2_b32 v[236:237], v97 offset0:176 offset1:177
  ds_read2_b32 v[238:239], v97 offset0:178 offset1:179
  ds_read2_b32 v[240:241], v98 offset0:48 offset1:49
  ds_read2_b32 v[242:243], v98 offset0:50 offset1:51
  ds_read2_b32 v[244:245], v98 offset0:176 offset1:177
  ds_read2_b32 v[246:247], v98 offset0:178 offset1:179
  ds_read2_b32 v[248:249], v99 offset0:48 offset1:49
  ds_read2_b32 v[250:251], v99 offset0:50 offset1:51
  ds_read2_b32 v[252:253], v99 offset0:176 offset1:177
  ds_read2_b32 v[254:255], v99 offset0:178 offset1:179
  s_mul_i32 s6, s69, 4352
  s_lshl_b32 s7, s70, 11
  s_add_u32 s6, s6, s7
  s_add_u32 s72, s6, 4718592
  v_lshlrev_b32 v10, 5, v11
  v_lshl_add_u32 v10, v12, 3, v10
  s_lshl_b32 s6, s4, 12
  s_add_u32 s6, s6, 143360
  v_lshlrev_b32 v13, 4, v1
  v_add_u32 v14, s6, v13
  s_xor_b32 s6, s4, 1
  s_lshl_b32 s6, s6, 12
  s_add_u32 s6, s6, 143360
  v_add_u32 v15, s6, v13
  v_and_b32 v13, 1, v12
  v_lshrrev_b32 v2, 1, v12
  v_lshlrev_b32 v13, 9, v13
  v_lshl_add_u32 v13, v2, 4, v13
  v_lshl_add_u32 v13, v11, 5, v13
  s_mul_i32 s6, s68, 4608
  s_lshl_b32 s7, s70, 11
  s_sub_u32 s6, s6, s7
  s_add_u32 s6, s6, 120312
  v_sub_u32 v8, s6, v10
  s_lshl_b32 s7, s70, 13
  s_add_u32 s7, s7, 126976
  v_lshlrev_b32 v11, 2, v10
  v_add_u32 v11, s7, v11
  s_lshl_b32 s7, s4, 11
  s_add_u32 s7, s7, 100352
  v_add_u32 v10, s7, v10
  s_waitcnt vmcnt(0) lgkmcnt(0)
  v_mov_b32 v16, 161776
  v_mov_b32 v17, 1
  s_mov_b64 exec, 1
  ds_add_u32 v16, v17
  s_mov_b64 exec, -1
  v_lshlrev_b32 v64, 16, v48
  v_and_b32 v65, s64, v48
  v_lshlrev_b32 v66, 16, v49
  v_and_b32 v67, s64, v49
  v_lshlrev_b32 v68, 16, v50
  v_and_b32 v69, s64, v50
  v_lshlrev_b32 v70, 16, v51
  v_and_b32 v71, s64, v51
  v_lshlrev_b32 v72, 16, v52
  v_and_b32 v73, s64, v52
  v_lshlrev_b32 v74, 16, v53
  v_and_b32 v75, s64, v53
  v_lshlrev_b32 v76, 16, v54
  v_and_b32 v77, s64, v54
  v_lshlrev_b32 v78, 16, v55
  v_and_b32 v79, s64, v55
  v_pk_add_f32 v[64:65], v[64:65], v[72:73]
  v_pk_add_f32 v[66:67], v[66:67], v[74:75]
  v_pk_add_f32 v[68:69], v[68:69], v[76:77]
  v_pk_add_f32 v[70:71], v[70:71], v[78:79]
  v_lshlrev_b32 v72, 16, v56
  v_and_b32 v73, s64, v56
  v_lshlrev_b32 v74, 16, v57
  v_and_b32 v75, s64, v57
  v_lshlrev_b32 v76, 16, v58
  v_and_b32 v77, s64, v58
  v_lshlrev_b32 v78, 16, v59
  v_and_b32 v79, s64, v59
  v_pk_add_f32 v[64:65], v[64:65], v[72:73]
  v_pk_add_f32 v[66:67], v[66:67], v[74:75]
  v_pk_add_f32 v[68:69], v[68:69], v[76:77]
  v_pk_add_f32 v[70:71], v[70:71], v[78:79]
  v_lshlrev_b32 v72, 16, v60
  v_and_b32 v73, s64, v60
  v_lshlrev_b32 v74, 16, v61
  v_and_b32 v75, s64, v61
  v_lshlrev_b32 v76, 16, v62
  v_and_b32 v77, s64, v62
  v_lshlrev_b32 v78, 16, v63
  v_and_b32 v79, s64, v63
  v_pk_add_f32 v[64:65], v[64:65], v[72:73]
  v_pk_add_f32 v[66:67], v[66:67], v[74:75]
  v_pk_add_f32 v[68:69], v[68:69], v[76:77]
  v_pk_add_f32 v[70:71], v[70:71], v[78:79]
  s_nop 1
  v_add_f32_dpp v64, v64, v64 row_ror:8 row_mask:0xf bank_mask:0xf
  v_add_f32_dpp v65, v65, v65 row_ror:8 row_mask:0xf bank_mask:0xf
  v_add_f32_dpp v66, v66, v66 row_ror:8 row_mask:0xf bank_mask:0xf
  v_add_f32_dpp v67, v67, v67 row_ror:8 row_mask:0xf bank_mask:0xf
  v_add_f32_dpp v68, v68, v68 row_ror:8 row_mask:0xf bank_mask:0xf
  v_add_f32_dpp v69, v69, v69 row_ror:8 row_mask:0xf bank_mask:0xf
  v_add_f32_dpp v70, v70, v70 row_ror:8 row_mask:0xf bank_mask:0xf
  v_add_f32_dpp v71, v71, v71 row_ror:8 row_mask:0xf bank_mask:0xf
  s_nop 1
  v_permlane32_swap_b32 v64, v68
  v_permlane32_swap_b32 v65, v69
  v_permlane32_swap_b32 v66, v70
  v_permlane32_swap_b32 v67, v71
  s_nop 1
  v_add_f32 v64, v64, v68
  v_add_f32 v65, v65, v69
  v_add_f32 v66, v66, v70
  v_add_f32 v67, v67, v71
  s_nop 1
  v_permlane16_swap_b32 v64, v66
  v_permlane16_swap_b32 v65, v67
  v_lshrrev_b32 v5, 4, v1
  v_lshlrev_b32 v5, 3, v5
  v_and_b32 v6, 7, v1
  v_lshl_add_u32 v5, v6, 5, v5
  s_lshl_b32 s6, s4, 8
  s_add_u32 s6, s6, 160256
  v_add_u32 v5, s6, v5
  v_add_f32 v64, v64, v66
  v_add_f32 v65, v65, v67
  ds_write_b64 v5, v[64:65]
  s_waitcnt lgkmcnt(0)
  v_mov_b32 v16, 161736
  v_mov_b32 v17, 1
  s_mov_b64 exec, 1
  ds_add_u32 v16, v17
  s_mov_b64 exec, -1
  v_mov_b32 v16, 161776
L_aw_45:
  ds_read_b32 v17, v16
  s_waitcnt lgkmcnt(0)
  v_readfirstlane_b32 s6, v17
  s_nop 1
  s_cmp_ge_u32 s6, 4
  s_cbranch_scc1 L_aw_45_ok
  s_branch L_aw_45
L_aw_45_ok:
  v_mov_b32 v2, 161744
L_aw_46:
  ds_read_b32 v3, v2
  s_waitcnt lgkmcnt(0)
  v_readfirstlane_b32 s6, v3
  s_nop 1
  s_cmp_ge_u32 s6, 1
  s_cbranch_scc1 L_aw_46_ok
  s_branch L_aw_46
L_aw_46_ok:
  s_setprio 1
  ds_read_b128 v[48:51], v9 offset:3584
  ds_read_b128 v[52:55], v9 offset:3072
  ds_read_b128 v[56:59], v9 offset:2560
  ds_read_b128 v[60:63], v9 offset:2048
  ds_read_b128 v[64:67], v9 offset:1536
  ds_read_b128 v[68:71], v9 offset:1024
  ds_read_b128 v[72:75], v9 offset:512
  ds_read_b128 v[76:79], v9 offset:0
  ds_read_b128 v[80:83], v9 offset:3648
  ds_read_b128 v[84:87], v9 offset:3136
  ds_read_b128 v[88:91], v9 offset:2624
  ds_read_b128 v[92:95], v9 offset:2112
  ds_read_b128 v[96:99], v9 offset:1600
  ds_read_b128 v[100:103], v9 offset:1088
  ds_read_b128 v[104:107], v9 offset:576
  ds_read_b128 v[108:111], v9 offset:64
  s_waitcnt lgkmcnt(15)
  v_mfma_f32_16x16x32_bf16 v[16:19], v[128:131], v[48:51], 0
  v_mfma_f32_16x16x32_bf16 v[20:23], v[132:135], v[48:51], 0
  v_mfma_f32_16x16x32_bf16 v[24:27], v[136:139], v[48:51], 0
  v_mfma_f32_16x16x32_bf16 v[28:31], v[140:143], v[48:51], 0
  v_mfma_f32_16x16x32_bf16 v[32:35], v[144:147], v[48:51], 0
  v_mfma_f32_16x16x32_bf16 v[36:39], v[148:151], v[48:51], 0
  v_mfma_f32_16x16x32_bf16 v[40:43], v[152:155], v[48:51], 0
  v_mfma_f32_16x16x32_bf16 v[44:47], v[156:159], v[48:51], 0
  s_waitcnt lgkmcnt(14)
  v_mfma_f32_16x16x32_bf16 v[20:23], v[128:131], v[52:55], v[20:23]
  v_mfma_f32_16x16x32_bf16 v[24:27], v[132:135], v[52:55], v[24:27]
  v_mfma_f32_16x16x32_bf16 v[28:31], v[136:139], v[52:55], v[28:31]
  v_mfma_f32_16x16x32_bf16 v[32:35], v[140:143], v[52:55], v[32:35]
  v_mfma_f32_16x16x32_bf16 v[36:39], v[144:147], v[52:55], v[36:39]
  v_mfma_f32_16x16x32_bf16 v[40:43], v[148:151], v[52:55], v[40:43]
  v_mfma_f32_16x16x32_bf16 v[44:47], v[152:155], v[52:55], v[44:47]
  s_waitcnt lgkmcnt(13)
  v_mfma_f32_16x16x32_bf16 v[24:27], v[128:131], v[56:59], v[24:27]
  v_mfma_f32_16x16x32_bf16 v[28:31], v[132:135], v[56:59], v[28:31]
  v_mfma_f32_16x16x32_bf16 v[32:35], v[136:139], v[56:59], v[32:35]
  v_mfma_f32_16x16x32_bf16 v[36:39], v[140:143], v[56:59], v[36:39]
  v_mfma_f32_16x16x32_bf16 v[40:43], v[144:147], v[56:59], v[40:43]
  v_mfma_f32_16x16x32_bf16 v[44:47], v[148:151], v[56:59], v[44:47]
  s_waitcnt lgkmcnt(12)
  v_mfma_f32_16x16x32_bf16 v[28:31], v[128:131], v[60:63], v[28:31]
  v_mfma_f32_16x16x32_bf16 v[32:35], v[132:135], v[60:63], v[32:35]
  v_mfma_f32_16x16x32_bf16 v[36:39], v[136:139], v[60:63], v[36:39]
  v_mfma_f32_16x16x32_bf16 v[40:43], v[140:143], v[60:63], v[40:43]
  v_mfma_f32_16x16x32_bf16 v[44:47], v[144:147], v[60:63], v[44:47]
  s_waitcnt lgkmcnt(11)
  v_mfma_f32_16x16x32_bf16 v[32:35], v[128:131], v[64:67], v[32:35]
  v_mfma_f32_16x16x32_bf16 v[36:39], v[132:135], v[64:67], v[36:39]
  v_mfma_f32_16x16x32_bf16 v[40:43], v[136:139], v[64:67], v[40:43]
  v_mfma_f32_16x16x32_bf16 v[44:47], v[140:143], v[64:67], v[44:47]
  s_waitcnt lgkmcnt(10)
  v_mfma_f32_16x16x32_bf16 v[36:39], v[128:131], v[68:71], v[36:39]
  v_mfma_f32_16x16x32_bf16 v[40:43], v[132:135], v[68:71], v[40:43]
  v_mfma_f32_16x16x32_bf16 v[44:47], v[136:139], v[68:71], v[44:47]
  s_waitcnt lgkmcnt(9)
  v_mfma_f32_16x16x32_bf16 v[40:43], v[128:131], v[72:75], v[40:43]
  v_mfma_f32_16x16x32_bf16 v[44:47], v[132:135], v[72:75], v[44:47]
  s_waitcnt lgkmcnt(8)
  v_mfma_f32_16x16x32_bf16 v[44:47], v[128:131], v[76:79], v[44:47]
  s_waitcnt lgkmcnt(0)
  v_mfma_f32_16x16x32_bf16 v[16:19], v[160:163], v[80:83], v[16:19]
  v_mfma_f32_16x16x32_bf16 v[20:23], v[164:167], v[80:83], v[20:23]
  v_mfma_f32_16x16x32_bf16 v[24:27], v[168:171], v[80:83], v[24:27]
  v_mfma_f32_16x16x32_bf16 v[28:31], v[172:175], v[80:83], v[28:31]
  ds_read_b128 v[48:51], v9 offset:3712
  v_mfma_f32_16x16x32_bf16 v[32:35], v[176:179], v[80:83], v[32:35]
  v_mfma_f32_16x16x32_bf16 v[36:39], v[180:183], v[80:83], v[36:39]
  v_mfma_f32_16x16x32_bf16 v[40:43], v[184:187], v[80:83], v[40:43]
  ds_read_b128 v[52:55], v9 offset:3200
  v_mfma_f32_16x16x32_bf16 v[44:47], v[188:191], v[80:83], v[44:47]
  v_mfma_f32_16x16x32_bf16 v[20:23], v[160:163], v[84:87], v[20:23]
  v_mfma_f32_16x16x32_bf16 v[24:27], v[164:167], v[84:87], v[24:27]
  ds_read_b128 v[56:59], v9 offset:2688
  v_mfma_f32_16x16x32_bf16 v[28:31], v[168:171], v[84:87], v[28:31]
  v_mfma_f32_16x16x32_bf16 v[32:35], v[172:175], v[84:87], v[32:35]
  v_mfma_f32_16x16x32_bf16 v[36:39], v[176:179], v[84:87], v[36:39]
  ds_read_b128 v[60:63], v9 offset:2176
  v_mfma_f32_16x16x32_bf16 v[40:43], v[180:183], v[84:87], v[40:43]
  v_mfma_f32_16x16x32_bf16 v[44:47], v[184:187], v[84:87], v[44:47]
  v_mfma_f32_16x16x32_bf16 v[24:27], v[160:163], v[88:91], v[24:27]
  ds_read_b128 v[64:67], v9 offset:1664
  v_mfma_f32_16x16x32_bf16 v[28:31], v[164:167], v[88:91], v[28:31]
  v_mfma_f32_16x16x32_bf16 v[32:35], v[168:171], v[88:91], v[32:35]
  v_mfma_f32_16x16x32_bf16 v[36:39], v[172:175], v[88:91], v[36:39]
  ds_read_b128 v[68:71], v9 offset:1152
  v_mfma_f32_16x16x32_bf16 v[40:43], v[176:179], v[88:91], v[40:43]
  v_mfma_f32_16x16x32_bf16 v[44:47], v[180:183], v[88:91], v[44:47]
  v_mfma_f32_16x16x32_bf16 v[28:31], v[160:163], v[92:95], v[28:31]
  ds_read_b128 v[72:75], v9 offset:640
  v_mfma_f32_16x16x32_bf16 v[32:35], v[164:167], v[92:95], v[32:35]
  v_mfma_f32_16x16x32_bf16 v[36:39], v[168:171], v[92:95], v[36:39]
  v_mfma_f32_16x16x32_bf16 v[40:43], v[172:175], v[92:95], v[40:43]
  ds_read_b128 v[76:79], v9 offset:128
  v_mfma_f32_16x16x32_bf16 v[44:47], v[176:179], v[92:95], v[44:47]
  v_mfma_f32_16x16x32_bf16 v[32:35], v[160:163], v[96:99], v[32:35]
  v_mfma_f32_16x16x32_bf16 v[36:39], v[164:167], v[96:99], v[36:39]
  v_mfma_f32_16x16x32_bf16 v[40:43], v[168:171], v[96:99], v[40:43]
  v_mfma_f32_16x16x32_bf16 v[44:47], v[172:175], v[96:99], v[44:47]
  v_mfma_f32_16x16x32_bf16 v[36:39], v[160:163], v[100:103], v[36:39]
  v_mfma_f32_16x16x32_bf16 v[40:43], v[164:167], v[100:103], v[40:43]
  v_mfma_f32_16x16x32_bf16 v[44:47], v[168:171], v[100:103], v[44:47]
  v_mfma_f32_16x16x32_bf16 v[40:43], v[160:163], v[104:107], v[40:43]
  v_mfma_f32_16x16x32_bf16 v[44:47], v[164:167], v[104:107], v[44:47]
  v_mfma_f32_16x16x32_bf16 v[44:47], v[160:163], v[108:111], v[44:47]
  s_waitcnt lgkmcnt(0)
  v_mfma_f32_16x16x32_bf16 v[16:19], v[192:195], v[48:51], v[16:19]
  v_mfma_f32_16x16x32_bf16 v[20:23], v[196:199], v[48:51], v[20:23]
  v_mfma_f32_16x16x32_bf16 v[24:27], v[200:203], v[48:51], v[24:27]
  v_mfma_f32_16x16x32_bf16 v[28:31], v[204:207], v[48:51], v[28:31]
  ds_read_b128 v[80:83], v9 offset:3776
  v_mfma_f32_16x16x32_bf16 v[32:35], v[208:211], v[48:51], v[32:35]
  v_mfma_f32_16x16x32_bf16 v[36:39], v[212:215], v[48:51], v[36:39]
  v_mfma_f32_16x16x32_bf16 v[40:43], v[216:219], v[48:51], v[40:43]
  ds_read_b128 v[84:87], v9 offset:3264
  v_mfma_f32_16x16x32_bf16 v[44:47], v[220:223], v[48:51], v[44:47]
  v_mfma_f32_16x16x32_bf16 v[20:23], v[192:195], v[52:55], v[20:23]
  v_mfma_f32_16x16x32_bf16 v[24:27], v[196:199], v[52:55], v[24:27]
  ds_read_b128 v[88:91], v9 offset:2752
  v_mfma_f32_16x16x32_bf16 v[28:31], v[200:203], v[52:55], v[28:31]
  v_mfma_f32_16x16x32_bf16 v[32:35], v[204:207], v[52:55], v[32:35]
  v_mfma_f32_16x16x32_bf16 v[36:39], v[208:211], v[52:55], v[36:39]
  ds_read_b128 v[92:95], v9 offset:2240
  v_mfma_f32_16x16x32_bf16 v[40:43], v[212:215], v[52:55], v[40:43]
  v_mfma_f32_16x16x32_bf16 v[44:47], v[216:219], v[52:55], v[44:47]
  v_mfma_f32_16x16x32_bf16 v[24:27], v[192:195], v[56:59], v[24:27]
  ds_read_b128 v[96:99], v9 offset:1728
  v_mfma_f32_16x16x32_bf16 v[28:31], v[196:199], v[56:59], v[28:31]
  v_mfma_f32_16x16x32_bf16 v[32:35], v[200:203], v[56:59], v[32:35]
  v_mfma_f32_16x16x32_bf16 v[36:39], v[204:207], v[56:59], v[36:39]
  ds_read_b128 v[100:103], v9 offset:1216
  v_mfma_f32_16x16x32_bf16 v[40:43], v[208:211], v[56:59], v[40:43]
  v_mfma_f32_16x16x32_bf16 v[44:47], v[212:215], v[56:59], v[44:47]
  v_mfma_f32_16x16x32_bf16 v[28:31], v[192:195], v[60:63], v[28:31]
  ds_read_b128 v[104:107], v9 offset:704
  v_mfma_f32_16x16x32_bf16 v[32:35], v[196:199], v[60:63], v[32:35]
  v_mfma_f32_16x16x32_bf16 v[36:39], v[200:203], v[60:63], v[36:39]
  v_mfma_f32_16x16x32_bf16 v[40:43], v[204:207], v[60:63], v[40:43]
  ds_read_b128 v[108:111], v9 offset:192
  v_mfma_f32_16x16x32_bf16 v[44:47], v[208:211], v[60:63], v[44:47]
  v_mfma_f32_16x16x32_bf16 v[32:35], v[192:195], v[64:67], v[32:35]
  v_mfma_f32_16x16x32_bf16 v[36:39], v[196:199], v[64:67], v[36:39]
  v_mfma_f32_16x16x32_bf16 v[40:43], v[200:203], v[64:67], v[40:43]
  v_mfma_f32_16x16x32_bf16 v[44:47], v[204:207], v[64:67], v[44:47]
  v_mfma_f32_16x16x32_bf16 v[36:39], v[192:195], v[68:71], v[36:39]
  v_mfma_f32_16x16x32_bf16 v[40:43], v[196:199], v[68:71], v[40:43]
  v_mfma_f32_16x16x32_bf16 v[44:47], v[200:203], v[68:71], v[44:47]
  v_mfma_f32_16x16x32_bf16 v[40:43], v[192:195], v[72:75], v[40:43]
  v_mfma_f32_16x16x32_bf16 v[44:47], v[196:199], v[72:75], v[44:47]
  v_mfma_f32_16x16x32_bf16 v[44:47], v[192:195], v[76:79], v[44:47]
  s_waitcnt lgkmcnt(0)
  v_mfma_f32_16x16x32_bf16 v[16:19], v[224:227], v[80:83], v[16:19]
  v_mfma_f32_16x16x32_bf16 v[20:23], v[228:231], v[80:83], v[20:23]
  v_mfma_f32_16x16x32_bf16 v[24:27], v[232:235], v[80:83], v[24:27]
  v_mfma_f32_16x16x32_bf16 v[28:31], v[236:239], v[80:83], v[28:31]
  v_mfma_f32_16x16x32_bf16 v[32:35], v[240:243], v[80:83], v[32:35]
  v_mfma_f32_16x16x32_bf16 v[36:39], v[244:247], v[80:83], v[36:39]
  v_mfma_f32_16x16x32_bf16 v[40:43], v[248:251], v[80:83], v[40:43]
  v_mfma_f32_16x16x32_bf16 v[44:47], v[252:255], v[80:83], v[44:47]
  v_mfma_f32_16x16x32_bf16 v[20:23], v[224:227], v[84:87], v[20:23]
  v_mfma_f32_16x16x32_bf16 v[24:27], v[228:231], v[84:87], v[24:27]
  v_mfma_f32_16x16x32_bf16 v[28:31], v[232:235], v[84:87], v[28:31]
  v_mfma_f32_16x16x32_bf16 v[32:35], v[236:239], v[84:87], v[32:35]
  v_mfma_f32_16x16x32_bf16 v[36:39], v[240:243], v[84:87], v[36:39]
  v_mfma_f32_16x16x32_bf16 v[40:43], v[244:247], v[84:87], v[40:43]
  v_mfma_f32_16x16x32_bf16 v[44:47], v[248:251], v[84:87], v[44:47]
  v_mfma_f32_16x16x32_bf16 v[24:27], v[224:227], v[88:91], v[24:27]
  v_mfma_f32_16x16x32_bf16 v[28:31], v[228:231], v[88:91], v[28:31]
  v_mfma_f32_16x16x32_bf16 v[32:35], v[232:235], v[88:91], v[32:35]
  v_mfma_f32_16x16x32_bf16 v[36:39], v[236:239], v[88:91], v[36:39]
  v_mfma_f32_16x16x32_bf16 v[40:43], v[240:243], v[88:91], v[40:43]
  v_mfma_f32_16x16x32_bf16 v[44:47], v[244:247], v[88:91], v[44:47]
  v_mfma_f32_16x16x32_bf16 v[28:31], v[224:227], v[92:95], v[28:31]
  v_mfma_f32_16x16x32_bf16 v[32:35], v[228:231], v[92:95], v[32:35]
  v_mfma_f32_16x16x32_bf16 v[36:39], v[232:235], v[92:95], v[36:39]
  v_mfma_f32_16x16x32_bf16 v[40:43], v[236:239], v[92:95], v[40:43]
  v_mfma_f32_16x16x32_bf16 v[44:47], v[240:243], v[92:95], v[44:47]
  v_mfma_f32_16x16x32_bf16 v[32:35], v[224:227], v[96:99], v[32:35]
  v_mfma_f32_16x16x32_bf16 v[36:39], v[228:231], v[96:99], v[36:39]
  v_mfma_f32_16x16x32_bf16 v[40:43], v[232:235], v[96:99], v[40:43]
  v_mfma_f32_16x16x32_bf16 v[44:47], v[236:239], v[96:99], v[44:47]
  v_mfma_f32_16x16x32_bf16 v[36:39], v[224:227], v[100:103], v[36:39]
  v_mfma_f32_16x16x32_bf16 v[40:43], v[228:231], v[100:103], v[40:43]
  v_mfma_f32_16x16x32_bf16 v[44:47], v[232:235], v[100:103], v[44:47]
  v_mfma_f32_16x16x32_bf16 v[40:43], v[224:227], v[104:107], v[40:43]
  v_mfma_f32_16x16x32_bf16 v[44:47], v[228:231], v[104:107], v[44:47]
  v_mfma_f32_16x16x32_bf16 v[44:47], v[224:227], v[108:111], v[44:47]
  s_cmp_eq_u32 s70, 0
  s_nop 6
  s_cbranch_scc1 L_cx_47_h0
  ds_write_b128 v14, v[16:19] offset:0
  ds_write_b128 v14, v[20:23] offset:1024
  ds_write_b128 v14, v[24:27] offset:2048
  ds_write_b128 v14, v[28:31] offset:3072
  s_nop 1
  v_mov_b32 v16, v32
  v_mov_b32 v17, v33
  v_mov_b32 v18, v34
  v_mov_b32 v19, v35
  v_mov_b32 v20, v36
  v_mov_b32 v21, v37
  v_mov_b32 v22, v38
  v_mov_b32 v23, v39
  v_mov_b32 v24, v40
  v_mov_b32 v25, v41
  v_mov_b32 v26, v42
  v_mov_b32 v27, v43
  v_mov_b32 v28, v44
  v_mov_b32 v29, v45
  v_mov_b32 v30, v46
  v_mov_b32 v31, v47
  s_branch L_cx_47_done
L_cx_47_h0:
  ds_write_b128 v14, v[32:35] offset:0
  ds_write_b128 v14, v[36:39] offset:1024
  ds_write_b128 v14, v[40:43] offset:2048
  ds_write_b128 v14, v[44:47] offset:3072
L_cx_47_done:
  v_mov_b32 v2, 161780
  v_mov_b32 v3, 1
  s_mov_b64 exec, 1
  ds_add_u32 v2, v3
  s_mov_b64 exec, -1
  v_mov_b32 v2, 161732
L_aw_48:
  ds_read_b32 v3, v2
  s_waitcnt lgkmcnt(0)
  v_readfirstlane_b32 s6, v3
  s_nop 1
  s_cmp_ge_u32 s6, 1
  s_cbranch_scc1 L_aw_48_ok
  s_branch L_aw_48
L_aw_48_ok:
  ds_read_b64 v[64:65], v8 offset:1536
  ds_read_b64 v[112:113], v10 offset:0
  ds_read_b128 v[72:75], v11 offset:0
  ds_read_b128 v[76:79], v11 offset:16
  ds_read_b64 v[66:67], v8 offset:1024
  ds_read_b64 v[114:115], v10 offset:512
  ds_read_b128 v[80:83], v11 offset:2048
  ds_read_b128 v[84:87], v11 offset:2064
  ds_read_b64 v[68:69], v8 offset:512
  ds_read_b64 v[116:117], v10 offset:1024
  ds_read_b128 v[88:91], v11 offset:4096
  ds_read_b128 v[92:95], v11 offset:4112
  ds_read_b64 v[70:71], v8 offset:0
  ds_read_b64 v[118:119], v10 offset:1536
  ds_read_b128 v[96:99], v11 offset:6144
  ds_read_b128 v[100:103], v11 offset:6160
  s_lshl_b32 s6, s71, 16
  s_and_b32 s7, s71, s64
  s_cmp_eq_u32 s68, 0
  s_cselect_b32 s71, s6, s7
  s_waitcnt lgkmcnt(12)
  v_and_b32 v104, s64, v65
  v_lshlrev_b32 v105, 16, v65
  v_and_b32 v106, s64, v64
  v_lshlrev_b32 v107, 16, v64
  v_lshlrev_b32 v128, 16, v112
  v_and_b32 v129, s64, v112
  v_lshlrev_b32 v130, 16, v113
  v_and_b32 v131, s64, v113
  v_fmac_f32 v16, s71, v104
  v_fmac_f32 v17, s71, v105
  v_fmac_f32 v18, s71, v106
  v_fmac_f32 v19, s71, v107
  v_sub_f32 v132, v128, v72
  v_sub_f32 v133, v129, v74
  v_sub_f32 v134, v130, v76
  v_sub_f32 v135, v131, v78
  v_mul_f32 v132, v132, v73
  v_mul_f32 v133, v133, v75
  v_mul_f32 v134, v134, v77
  v_mul_f32 v135, v135, v79
  v_pk_fma_f32 v[128:129], v[132:133], v[16:17], v[128:129]
  v_pk_fma_f32 v[130:131], v[134:135], v[18:19], v[130:131]
  s_waitcnt lgkmcnt(8)
  v_and_b32 v104, s64, v67
  v_lshlrev_b32 v105, 16, v67
  v_and_b32 v106, s64, v66
  v_lshlrev_b32 v107, 16, v66
  v_lshlrev_b32 v136, 16, v114
  v_and_b32 v137, s64, v114
  v_lshlrev_b32 v138, 16, v115
  v_and_b32 v139, s64, v115
  v_fmac_f32 v20, s71, v104
  v_fmac_f32 v21, s71, v105
  v_fmac_f32 v22, s71, v106
  v_fmac_f32 v23, s71, v107
  v_sub_f32 v140, v136, v80
  v_sub_f32 v141, v137, v82
  v_sub_f32 v142, v138, v84
  v_sub_f32 v143, v139, v86
  v_mul_f32 v140, v140, v81
  v_mul_f32 v141, v141, v83
  v_mul_f32 v142, v142, v85
  v_mul_f32 v143, v143, v87
  v_pk_fma_f32 v[136:137], v[140:141], v[20:21], v[136:137]
  v_pk_fma_f32 v[138:139], v[142:143], v[22:23], v[138:139]
  s_waitcnt lgkmcnt(4)
  v_and_b32 v104, s64, v69
  v_lshlrev_b32 v105, 16, v69
  v_and_b32 v106, s64, v68
  v_lshlrev_b32 v107, 16, v68
  v_lshlrev_b32 v144, 16, v116
  v_and_b32 v145, s64, v116
  v_lshlrev_b32 v146, 16, v117
  v_and_b32 v147, s64, v117
  v_fmac_f32 v24, s71, v104
  v_fmac_f32 v25, s71, v105
  v_fmac_f32 v26, s71, v106
  v_fmac_f32 v27, s71, v107
  v_sub_f32 v148, v144, v88
  v_sub_f32 v149, v145, v90
  v_sub_f32 v150, v146, v92
  v_sub_f32 v151, v147, v94
  v_mul_f32 v148, v148, v89
  v_mul_f32 v149, v149, v91
  v_mul_f32 v150, v150, v93
  v_mul_f32 v151, v151, v95
  v_pk_fma_f32 v[144:145], v[148:149], v[24:25], v[144:145]
  v_pk_fma_f32 v[146:147], v[150:151], v[26:27], v[146:147]
  s_waitcnt lgkmcnt(0)
  v_and_b32 v104, s64, v71
  v_lshlrev_b32 v105, 16, v71
  v_and_b32 v106, s64, v70
  v_lshlrev_b32 v107, 16, v70
  v_lshlrev_b32 v152, 16, v118
  v_and_b32 v153, s64, v118
  v_lshlrev_b32 v154, 16, v119
  v_and_b32 v155, s64, v119
  v_fmac_f32 v28, s71, v104
  v_fmac_f32 v29, s71, v105
  v_fmac_f32 v30, s71, v106
  v_fmac_f32 v31, s71, v107
  v_sub_f32 v156, v152, v96
  v_sub_f32 v157, v153, v98
  v_sub_f32 v158, v154, v100
  v_sub_f32 v159, v155, v102
  v_mul_f32 v156, v156, v97
  v_mul_f32 v157, v157, v99
  v_mul_f32 v158, v158, v101
  v_mul_f32 v159, v159, v103
  v_pk_fma_f32 v[152:153], v[156:157], v[28:29], v[152:153]
  v_pk_fma_f32 v[154:155], v[158:159], v[30:31], v[154:155]
  v_mov_b32 v2, 161780
L_aw_49:
  ds_read_b32 v3, v2
  s_waitcnt lgkmcnt(0)
  v_readfirstlane_b32 s6, v3
  s_nop 1
  s_cmp_ge_u32 s6, 4
  s_cbranch_scc1 L_aw_49_ok
  s_branch L_aw_49
L_aw_49_ok:
  ds_read_b128 v[32:35], v15 offset:0
  ds_read_b128 v[36:39], v15 offset:1024
  ds_read_b128 v[40:43], v15 offset:2048
  ds_read_b128 v[44:47], v15 offset:3072
  s_waitcnt lgkmcnt(3)
  v_pk_fma_f32 v[128:129], v[132:133], v[32:33], v[128:129]
  v_pk_fma_f32 v[130:131], v[134:135], v[34:35], v[130:131]
  v_cvt_pk_bf16_f32 v120, v128, v129
  v_cvt_pk_bf16_f32 v121, v130, v131
  s_waitcnt lgkmcnt(2)
  v_pk_fma_f32 v[136:137], v[140:141], v[36:37], v[136:137]
  v_pk_fma_f32 v[138:139], v[142:143], v[38:39], v[138:139]
  v_cvt_pk_bf16_f32 v122, v136, v137
  v_cvt_pk_bf16_f32 v123, v138, v139
  s_nop 1
  v_permlane16_swap_b32 v120, v122
  v_permlane16_swap_b32 v121, v123
  buffer_store_dwordx4 v[120:123], v13, s[44:47], s72 offen offset:0 sc1
  s_waitcnt lgkmcnt(1)
  v_pk_fma_f32 v[144:145], v[148:149], v[40:41], v[144:145]
  v_pk_fma_f32 v[146:147], v[150:151], v[42:43], v[146:147]
  v_cvt_pk_bf16_f32 v124, v144, v145
  v_cvt_pk_bf16_f32 v125, v146, v147
  s_waitcnt lgkmcnt(0)
  v_pk_fma_f32 v[152:153], v[156:157], v[44:45], v[152:153]
  v_pk_fma_f32 v[154:155], v[158:159], v[46:47], v[154:155]
  v_cvt_pk_bf16_f32 v126, v152, v153
  v_cvt_pk_bf16_f32 v127, v154, v155
  s_nop 1
  v_permlane16_swap_b32 v124, v126
  v_permlane16_swap_b32 v125, v127
  buffer_store_dwordx4 v[124:127], v13, s[44:47], s72 offen offset:1024 sc1
  s_waitcnt vmcnt(0)
  v_mov_b32 v2, 161740
  v_mov_b32 v3, 1
  s_mov_b64 exec, 1
  ds_add_rtn_u32 v4, v2, v3
  s_mov_b64 exec, -1
  s_waitcnt lgkmcnt(0)
  v_readfirstlane_b32 s6, v4
  s_nop 1
  s_cmp_lg_u32 s6, 4
  s_cbranch_scc1 L_arr_50
  v_mov_b32 v2, s74
  v_mov_b32 v3, s75
  v_mov_b32 v4, 0
  s_lshl_b32 s6, s2, 4
  s_add_u32 s6, s6, 14458880
  s_mov_b64 exec, 1
  buffer_store_dwordx2 v[2:3], v4, s[44:47], s6 offen sc1
  s_mov_b64 exec, -1
L_arr_50:
  s_mov_b32 s52, s34
  s_mov_b32 s53, s35
  s_mov_b32 s54, 1835008
  s_mov_b32 s55, 0x00020000
  s_mul_i32 s6, s2, 7168
  s_mul_i32 s7, s4, 1792
  s_add_u32 s6, s6, s7
  v_min_u32 v13, 13, v1
  v_lshlrev_b32 v13, 7, v13
  buffer_load_dword v252, v13, s[52:55], s6 offen
  s_and_b32 s6, s2, 7
  s_lshr_b32 s7, s2, 3
  s_lshr_b32 s8, s6, 1
  s_lshl_b32 s8, s8, 2
  s_and_b32 s9, s7, 3
  s_add_u32 s76, s8, s9
  s_and_b32 s8, s6, 1
  s_lshl_b32 s8, s8, 3
  s_lshr_b32 s9, s7, 2
  s_add_u32 s77, s8, s9
  s_lshl_b32 s8, s76, 4
  s_add_u32 s78, s8, s77
  s_and_b32 s8, s76, 3
  s_lshl_b32 s8, s8, 2
  s_add_u32 s8, s8, s77
  s_and_b32 s5, s8, 15
  s_mov_b32 s56, s34
  s_mov_b32 s57, s35
  s_mov_b32 s58, 1835008
  s_mov_b32 s59, 0x00020000
  s_and_b32 s10, s76, 3
  s_lshl_b32 s10, s10, 2
  s_add_u32 s10, s10, s4
  s_lshl_b32 s10, s10, 14
  s_and_b32 s11, s77, 7
  s_lshl_b32 s11, s11, 7
  s_add_u32 s10, s10, s11
  s_and_b32 s11, s77, 0
  s_lshl_b32 s11, s11, 0
  s_add_u32 s11, s11, 2
  s_and_b32 s11, s11, 3
  s_mul_i32 s11, s11, 229376
  s_add_u32 s10, s10, s11
  v_bfe_u32 v17, v1, 4, 1
  v_mul_u32_u24 v17, 896, v17
  v_and_b32 v18, 15, v1
  v_add_u32 v17, v17, v18
  v_lshlrev_b32 v17, 10, v17
  buffer_load_dword v254, v17, s[56:59], s10 offen
  s_and_b32 s6, s4, 1
  s_lshr_b32 s7, s4, 1
  v_lshrrev_b32 v14, 2, v1
  v_and_b32 v15, 3, v1
  v_lshlrev_b32 v15, 3, v15
  v_mul_u32_u24 v16, 224, v14
  v_add_u32 v16, v16, v15
  s_lshl_b32 s8, s7, 7
  v_add_u32 v2, s8, v16
  v_add_u32 v3, 57344, v2
  v_add_u32 v4, 96, v16
  v_add_u32 v5, 57440, v16
  v_lshl_add_u32 v16, v14, 8, v15
  v_add_u32 v16, 100352, v16
  v_and_b32 v17, 7, v14
  s_lshl_b32 s8, s6, 2
  s_lshl_b32 s9, s7, 1
  s_xor_b32 s10, s9, 0
  s_add_u32 s10, s10, s8
  v_xor_b32 v18, s10, v17
  v_lshl_add_u32 v6, v18, 5, v16
  s_xor_b32 s10, s9, 1
  s_add_u32 s10, s10, s8
  v_xor_b32 v18, s10, v17
  v_lshl_add_u32 v7, v18, 5, v16
  s_xor_b32 s10, s9, 2
  s_add_u32 s10, s10, s8
  v_xor_b32 v18, s10, v17
  v_lshl_add_u32 v8, v18, 5, v16
  s_xor_b32 s10, s9, 3
  s_add_u32 s10, s10, s8
  v_xor_b32 v18, s10, v17
  v_lshl_add_u32 v9, v18, 5, v16
  v_and_b32 v14, 15, v1
  v_lshrrev_b32 v15, 4, v1
  s_add_u32 s10, s8, s9
  s_lshl_b32 s10, s10, 4
  v_add_u32 v16, s10, v14
  v_lshlrev_b32 v13, 4, v16
  v_add_u32 v13, 161792, v13
  v_lshlrev_b32 v10, 4, v1
  s_mul_i32 s10, s78, 28672
  s_add_u32 s10, s10, 7077888
  s_lshl_b32 s11, s6, 1
  s_add_u32 s12, s11, s7
  s_mul_i32 s12, s12, 7168
  s_add_u32 s12, s12, s10
  s_add_u32 s85, s12, 3072
  s_lshl_b32 s13, s7, 12
  s_add_u32 s83, s12, s13
  s_xor_b32 s12, s7, 1
  s_add_u32 s12, s12, s11
  s_mul_i32 s12, s12, 7168
  s_add_u32 s12, s12, s10
  s_add_u32 s84, s12, s13
  s_xor_b32 s10, s9, 2
  s_add_u32 s10, s10, s8
  v_lshrrev_b32 v17, 5, v1
  v_add_u32 v17, s10, v17
  v_lshl_add_u32 v17, v17, 4, v14
  v_lshlrev_b32 v14, 4, v17
  s_lshl_b32 s10, s76, 4
  s_add_u32 s10, s10, s5
  s_lshl_b32 s10, s10, 11
  s_add_u32 s12, s10, 14745600
  v_mov_b32 v226, s74
  v_mov_b32 v227, s75
  s_mul_i32 s82, s7, -1024
  s_add_u32 s82, s82, 512
  v_lshlrev_b32 v12, 4, v15
  v_add_u32 v12, 158208, v12
  s_lshl_b32 s11, s7, 8
  v_add_u32 v11, s11, v12
  s_and_b32 s86, s4, 1
  s_lshr_b32 s87, s4, 1
  v_lshrrev_b32 v16, 4, v1
  v_bfe_u32 v17, v1, 2, 2
  v_lshl_add_u32 v17, v16, 3, v17
  v_lshlrev_b32 v17, 7, v17
  v_and_b32 v18, 3, v1
  v_lshl_add_u32 v17, v18, 3, v17
  v_bfe_u32 v18, v1, 3, 2
  s_lshl_b32 s6, s87, 1
  v_xor_b32 v18, s6, v18
  s_lshl_b32 s7, s86, 12
  v_add_u32 v17, s7, v17
  v_lshl_add_u32 v15, v18, 5, v17
  s_barrier
  ds_read_b64_tr_b16 v[160:161], v6 offset:0
  ds_read_b64_tr_b16 v[162:163], v6 offset:4096
  ds_read_b64_tr_b16 v[128:129], v2 offset:0
  ds_read_b64_tr_b16 v[130:131], v2 offset:3584
  ds_read_b64_tr_b16 v[164:165], v7 offset:0
  ds_read_b64_tr_b16 v[166:167], v7 offset:4096
  ds_read_b64_tr_b16 v[168:169], v8 offset:0
  ds_read_b64_tr_b16 v[170:171], v8 offset:4096
  ds_read_b64_tr_b16 v[172:173], v9 offset:0
  ds_read_b64_tr_b16 v[174:175], v9 offset:4096
  ds_read_b64_tr_b16 v[132:133], v2 offset:7168
  ds_read_b64_tr_b16 v[134:135], v2 offset:10752
  ds_read_b64_tr_b16 v[136:137], v2 offset:32
  ds_read_b64_tr_b16 v[138:139], v2 offset:3616
  ds_read_b64_tr_b16 v[140:141], v2 offset:7200
  ds_read_b64_tr_b16 v[142:143], v2 offset:10784
  ds_read_b64_tr_b16 v[144:145], v2 offset:64
  ds_read_b64_tr_b16 v[146:147], v2 offset:3648
  ds_read_b64_tr_b16 v[148:149], v2 offset:7232
  ds_read_b64_tr_b16 v[150:151], v2 offset:10816
  ds_read_b64_tr_b16 v[152:153], v4 offset:0
  ds_read_b64_tr_b16 v[154:155], v4 offset:3584
  ds_read_b64_tr_b16 v[156:157], v4 offset:7168
  ds_read_b64_tr_b16 v[158:159], v4 offset:10752
  s_waitcnt lgkmcnt(0)
  v_mfma_f32_16x16x32_bf16 v[16:19], v[128:131], v[160:163], 0
  ds_read_b64_tr_b16 v[208:209], v6 offset:8192
  v_mfma_f32_16x16x32_bf16 v[20:23], v[128:131], v[164:167], 0
  ds_read_b64_tr_b16 v[210:211], v6 offset:12288
  v_mfma_f32_16x16x32_bf16 v[24:27], v[128:131], v[168:171], 0
  ds_read_b64_tr_b16 v[176:177], v2 offset:14336
  v_mfma_f32_16x16x32_bf16 v[28:31], v[128:131], v[172:175], 0
  v_lshlrev_b32 v232, 16, v168
  ds_read_b64_tr_b16 v[178:179], v2 offset:17920
  v_mfma_f32_16x16x32_bf16 v[32:35], v[132:135], v[160:163], 0
  ds_read_b64_tr_b16 v[212:213], v7 offset:8192
  v_mfma_f32_16x16x32_bf16 v[36:39], v[132:135], v[164:167], 0
  v_and_b32 v233, s64, v168
  ds_read_b64_tr_b16 v[214:215], v7 offset:12288
  v_mfma_f32_16x16x32_bf16 v[40:43], v[132:135], v[168:171], 0
  ds_read_b64_tr_b16 v[216:217], v8 offset:8192
  v_mfma_f32_16x16x32_bf16 v[44:47], v[132:135], v[172:175], 0
  v_lshlrev_b32 v234, 16, v169
  ds_read_b64_tr_b16 v[218:219], v8 offset:12288
  v_mfma_f32_16x16x32_bf16 v[48:51], v[136:139], v[160:163], 0
  ds_read_b64_tr_b16 v[220:221], v9 offset:8192
  v_mfma_f32_16x16x32_bf16 v[52:55], v[136:139], v[164:167], 0
  v_and_b32 v235, s64, v169
  ds_read_b64_tr_b16 v[222:223], v9 offset:12288
  v_mfma_f32_16x16x32_bf16 v[56:59], v[136:139], v[168:171], 0
  ds_read_b64_tr_b16 v[180:181], v2 offset:21504
  v_mfma_f32_16x16x32_bf16 v[60:63], v[136:139], v[172:175], 0
  v_lshlrev_b32 v236, 16, v170
  ds_read_b64_tr_b16 v[182:183], v2 offset:25088
  v_mfma_f32_16x16x32_bf16 v[64:67], v[140:143], v[160:163], 0
  ds_read_b64_tr_b16 v[184:185], v2 offset:14368
  v_mfma_f32_16x16x32_bf16 v[68:71], v[140:143], v[164:167], 0
  v_and_b32 v237, s64, v170
  ds_read_b64_tr_b16 v[186:187], v2 offset:17952
  v_mfma_f32_16x16x32_bf16 v[72:75], v[140:143], v[168:171], 0
  ds_read_b64_tr_b16 v[188:189], v2 offset:21536
  v_mfma_f32_16x16x32_bf16 v[76:79], v[140:143], v[172:175], 0
  v_lshlrev_b32 v238, 16, v171
  ds_read_b64_tr_b16 v[190:191], v2 offset:25120
  v_mfma_f32_16x16x32_bf16 v[80:83], v[144:147], v[160:163], 0
  ds_read_b64_tr_b16 v[192:193], v2 offset:14400
  v_mfma_f32_16x16x32_bf16 v[84:87], v[144:147], v[164:167], 0
  v_and_b32 v239, s64, v171
  ds_read_b64_tr_b16 v[194:195], v2 offset:17984
  v_mfma_f32_16x16x32_bf16 v[88:91], v[144:147], v[168:171], 0
  ds_read_b64_tr_b16 v[196:197], v2 offset:21568
  v_mfma_f32_16x16x32_bf16 v[92:95], v[144:147], v[172:175], 0
  v_lshlrev_b32 v240, 16, v172
  ds_read_b64_tr_b16 v[198:199], v2 offset:25152
  v_mfma_f32_16x16x32_bf16 v[96:99], v[148:151], v[160:163], 0
  ds_read_b64_tr_b16 v[200:201], v4 offset:14336
  v_mfma_f32_16x16x32_bf16 v[100:103], v[148:151], v[164:167], 0
  v_and_b32 v241, s64, v172
  ds_read_b64_tr_b16 v[202:203], v4 offset:17920
  v_mfma_f32_16x16x32_bf16 v[104:107], v[148:151], v[168:171], 0
  ds_read_b64_tr_b16 v[204:205], v4 offset:21504
  v_mfma_f32_16x16x32_bf16 v[108:111], v[148:151], v[172:175], 0
  ds_read_b64_tr_b16 v[206:207], v4 offset:25088
  v_mfma_f32_16x16x32_bf16 v[112:115], v[152:155], v[160:163], 0
  v_mfma_f32_16x16x32_bf16 v[116:119], v[152:155], v[164:167], 0
  v_lshlrev_b32 v242, 16, v173
  v_and_b32 v243, s64, v173
  v_mfma_f32_16x16x32_bf16 v[120:123], v[156:159], v[160:163], 0
  v_lshlrev_b32 v244, 16, v174
  v_and_b32 v245, s64, v174
  v_mfma_f32_16x16x32_bf16 v[124:127], v[156:159], v[164:167], 0
  v_lshlrev_b32 v246, 16, v175
  v_and_b32 v247, s64, v175
  s_waitcnt lgkmcnt(0)
  s_barrier
  v_mfma_f32_16x16x32_bf16 v[16:19], v[176:179], v[208:211], v[16:19]
  ds_read_b64_tr_b16 v[160:161], v6 offset:16384
  v_mfma_f32_16x16x32_bf16 v[20:23], v[176:179], v[212:215], v[20:23]
  ds_read_b64_tr_b16 v[162:163], v6 offset:20480
  v_mfma_f32_16x16x32_bf16 v[24:27], v[176:179], v[216:219], v[24:27]
  ds_read_b64_tr_b16 v[128:129], v2 offset:28672
  v_mfma_f32_16x16x32_bf16 v[28:31], v[176:179], v[220:223], v[28:31]
  v_mul_f32 v225, v232, v232
  ds_read_b64_tr_b16 v[130:131], v2 offset:32256
  v_mfma_f32_16x16x32_bf16 v[32:35], v[180:183], v[208:211], v[32:35]
  ds_read_b64_tr_b16 v[164:165], v7 offset:16384
  v_mfma_f32_16x16x32_bf16 v[36:39], v[180:183], v[212:215], v[36:39]
  v_mul_f32 v229, v240, v240
  ds_read_b64_tr_b16 v[166:167], v7 offset:20480
  v_mfma_f32_16x16x32_bf16 v[40:43], v[180:183], v[216:219], v[40:43]
  ds_read_b64_tr_b16 v[168:169], v8 offset:16384
  v_mfma_f32_16x16x32_bf16 v[44:47], v[180:183], v[220:223], v[44:47]
  ds_read_b64_tr_b16 v[170:171], v8 offset:20480
  v_mfma_f32_16x16x32_bf16 v[48:51], v[184:187], v[208:211], v[48:51]
  ds_read_b64_tr_b16 v[172:173], v9 offset:16384
  v_mfma_f32_16x16x32_bf16 v[52:55], v[184:187], v[212:215], v[52:55]
  ds_read_b64_tr_b16 v[174:175], v9 offset:20480
  v_mfma_f32_16x16x32_bf16 v[56:59], v[184:187], v[216:219], v[56:59]
  ds_read_b64_tr_b16 v[132:133], v2 offset:35840
  v_mfma_f32_16x16x32_bf16 v[60:63], v[184:187], v[220:223], v[60:63]
  ds_read_b64_tr_b16 v[134:135], v2 offset:39424
  v_mfma_f32_16x16x32_bf16 v[64:67], v[188:191], v[208:211], v[64:67]
  ds_read_b64_tr_b16 v[136:137], v2 offset:28704
  v_mfma_f32_16x16x32_bf16 v[68:71], v[188:191], v[212:215], v[68:71]
  ds_read_b64_tr_b16 v[138:139], v2 offset:32288
  v_mfma_f32_16x16x32_bf16 v[72:75], v[188:191], v[216:219], v[72:75]
  ds_read_b64_tr_b16 v[140:141], v2 offset:35872
  v_mfma_f32_16x16x32_bf16 v[76:79], v[188:191], v[220:223], v[76:79]
  ds_read_b64_tr_b16 v[142:143], v2 offset:39456
  v_mfma_f32_16x16x32_bf16 v[80:83], v[192:195], v[208:211], v[80:83]
  ds_read_b64_tr_b16 v[144:145], v2 offset:28736
  v_mfma_f32_16x16x32_bf16 v[84:87], v[192:195], v[212:215], v[84:87]
  ds_read_b64_tr_b16 v[146:147], v2 offset:32320
  v_mfma_f32_16x16x32_bf16 v[88:91], v[192:195], v[216:219], v[88:91]
  ds_read_b64_tr_b16 v[148:149], v2 offset:35904
  v_mfma_f32_16x16x32_bf16 v[92:95], v[192:195], v[220:223], v[92:95]
  ds_read_b64_tr_b16 v[150:151], v2 offset:39488
  v_mfma_f32_16x16x32_bf16 v[96:99], v[196:199], v[208:211], v[96:99]
  ds_read_b64_tr_b16 v[152:153], v4 offset:28672
  v_mfma_f32_16x16x32_bf16 v[100:103], v[196:199], v[212:215], v[100:103]
  ds_read_b64_tr_b16 v[154:155], v4 offset:32256
  v_mfma_f32_16x16x32_bf16 v[104:107], v[196:199], v[216:219], v[104:107]
  ds_read_b64_tr_b16 v[156:157], v4 offset:35840
  v_mfma_f32_16x16x32_bf16 v[108:111], v[196:199], v[220:223], v[108:111]
  ds_read_b64_tr_b16 v[158:159], v4 offset:39424
  v_mfma_f32_16x16x32_bf16 v[112:115], v[200:203], v[208:211], v[112:115]
  v_mfma_f32_16x16x32_bf16 v[116:119], v[200:203], v[212:215], v[116:119]
  v_add_f32 v224, v233, v232
  v_fmac_f32 v225, v233, v233
  v_mfma_f32_16x16x32_bf16 v[120:123], v[204:207], v[208:211], v[120:123]
  v_add_f32 v228, v241, v240
  v_fmac_f32 v229, v241, v241
  v_mfma_f32_16x16x32_bf16 v[124:127], v[204:207], v[212:215], v[124:127]
  v_add_f32 v224, v234, v224
  v_fmac_f32 v225, v234, v234
  s_waitcnt lgkmcnt(0)
  v_mfma_f32_16x16x32_bf16 v[16:19], v[128:131], v[160:163], v[16:19]
  ds_read_b64_tr_b16 v[208:209], v6 offset:24576
  v_mfma_f32_16x16x32_bf16 v[20:23], v[128:131], v[164:167], v[20:23]
  ds_read_b64_tr_b16 v[210:211], v6 offset:28672
  v_mfma_f32_16x16x32_bf16 v[24:27], v[128:131], v[168:171], v[24:27]
  ds_read_b64_tr_b16 v[176:177], v2 offset:43008
  v_mfma_f32_16x16x32_bf16 v[28:31], v[128:131], v[172:175], v[28:31]
  v_add_f32 v228, v242, v228
  ds_read_b64_tr_b16 v[178:179], v2 offset:46592
  v_mfma_f32_16x16x32_bf16 v[32:35], v[132:135], v[160:163], v[32:35]
  ds_read_b64_tr_b16 v[212:213], v7 offset:24576
  v_mfma_f32_16x16x32_bf16 v[36:39], v[132:135], v[164:167], v[36:39]
  v_fmac_f32 v229, v242, v242
  ds_read_b64_tr_b16 v[214:215], v7 offset:28672
  v_mfma_f32_16x16x32_bf16 v[40:43], v[132:135], v[168:171], v[40:43]
  ds_read_b64_tr_b16 v[216:217], v8 offset:24576
  v_mfma_f32_16x16x32_bf16 v[44:47], v[132:135], v[172:175], v[44:47]
  ds_read_b64_tr_b16 v[218:219], v8 offset:28672
  v_mfma_f32_16x16x32_bf16 v[48:51], v[136:139], v[160:163], v[48:51]
  ds_read_b64_tr_b16 v[220:221], v9 offset:24576
  v_mfma_f32_16x16x32_bf16 v[52:55], v[136:139], v[164:167], v[52:55]
  ds_read_b64_tr_b16 v[222:223], v9 offset:28672
  v_mfma_f32_16x16x32_bf16 v[56:59], v[136:139], v[168:171], v[56:59]
  ds_read_b64_tr_b16 v[180:181], v2 offset:50176
  v_mfma_f32_16x16x32_bf16 v[60:63], v[136:139], v[172:175], v[60:63]
  ds_read_b64_tr_b16 v[182:183], v2 offset:53760
  v_mfma_f32_16x16x32_bf16 v[64:67], v[140:143], v[160:163], v[64:67]
  ds_read_b64_tr_b16 v[184:185], v2 offset:43040
  v_mfma_f32_16x16x32_bf16 v[68:71], v[140:143], v[164:167], v[68:71]
  ds_read_b64_tr_b16 v[186:187], v2 offset:46624
  v_mfma_f32_16x16x32_bf16 v[72:75], v[140:143], v[168:171], v[72:75]
  ds_read_b64_tr_b16 v[188:189], v2 offset:50208
  v_mfma_f32_16x16x32_bf16 v[76:79], v[140:143], v[172:175], v[76:79]
  ds_read_b64_tr_b16 v[190:191], v2 offset:53792
  v_mfma_f32_16x16x32_bf16 v[80:83], v[144:147], v[160:163], v[80:83]
  ds_read_b64_tr_b16 v[192:193], v2 offset:43072
  v_mfma_f32_16x16x32_bf16 v[84:87], v[144:147], v[164:167], v[84:87]
  ds_read_b64_tr_b16 v[194:195], v2 offset:46656
  v_mfma_f32_16x16x32_bf16 v[88:91], v[144:147], v[168:171], v[88:91]
  ds_read_b64_tr_b16 v[196:197], v2 offset:50240
  v_mfma_f32_16x16x32_bf16 v[92:95], v[144:147], v[172:175], v[92:95]
  ds_read_b64_tr_b16 v[198:199], v2 offset:53824
  v_mfma_f32_16x16x32_bf16 v[96:99], v[148:151], v[160:163], v[96:99]
  ds_read_b64_tr_b16 v[200:201], v4 offset:43008
  v_mfma_f32_16x16x32_bf16 v[100:103], v[148:151], v[164:167], v[100:103]
  ds_read_b64_tr_b16 v[202:203], v4 offset:46592
  v_mfma_f32_16x16x32_bf16 v[104:107], v[148:151], v[168:171], v[104:107]
  ds_read_b64_tr_b16 v[204:205], v4 offset:50176
  v_mfma_f32_16x16x32_bf16 v[108:111], v[148:151], v[172:175], v[108:111]
  ds_read_b64_tr_b16 v[206:207], v4 offset:53760
  v_mfma_f32_16x16x32_bf16 v[112:115], v[152:155], v[160:163], v[112:115]
  v_mfma_f32_16x16x32_bf16 v[116:119], v[152:155], v[164:167], v[116:119]
  v_add_f32 v224, v235, v224
  v_fmac_f32 v225, v235, v235
  v_mfma_f32_16x16x32_bf16 v[120:123], v[156:159], v[160:163], v[120:123]
  v_add_f32 v228, v243, v228
  v_fmac_f32 v229, v243, v243
  v_mfma_f32_16x16x32_bf16 v[124:127], v[156:159], v[164:167], v[124:127]
  v_add_f32 v224, v236, v224
  v_fmac_f32 v225, v236, v236
  s_waitcnt lgkmcnt(0)
  s_barrier
  v_mfma_f32_16x16x32_bf16 v[16:19], v[176:179], v[208:211], v[16:19]
  ds_read_b64_tr_b16 v[160:161], v6 offset:32768
  v_mfma_f32_16x16x32_bf16 v[20:23], v[176:179], v[212:215], v[20:23]
  ds_read_b64_tr_b16 v[162:163], v6 offset:36864
  v_mfma_f32_16x16x32_bf16 v[24:27], v[176:179], v[216:219], v[24:27]
  ds_read_b64_tr_b16 v[128:129], v3 offset:0
  v_mfma_f32_16x16x32_bf16 v[28:31], v[176:179], v[220:223], v[28:31]
  v_add_f32 v228, v244, v228
  ds_read_b64_tr_b16 v[130:131], v3 offset:3584
  v_mfma_f32_16x16x32_bf16 v[32:35], v[180:183], v[208:211], v[32:35]
  ds_read_b64_tr_b16 v[164:165], v7 offset:32768
  v_mfma_f32_16x16x32_bf16 v[36:39], v[180:183], v[212:215], v[36:39]
  v_fmac_f32 v229, v244, v244
  ds_read_b64_tr_b16 v[166:167], v7 offset:36864
  v_mfma_f32_16x16x32_bf16 v[40:43], v[180:183], v[216:219], v[40:43]
  ds_read_b64_tr_b16 v[168:169], v8 offset:32768
  v_mfma_f32_16x16x32_bf16 v[44:47], v[180:183], v[220:223], v[44:47]
  ds_read_b64_tr_b16 v[170:171], v8 offset:36864
  v_mfma_f32_16x16x32_bf16 v[48:51], v[184:187], v[208:211], v[48:51]
  ds_read_b64_tr_b16 v[172:173], v9 offset:32768
  v_mfma_f32_16x16x32_bf16 v[52:55], v[184:187], v[212:215], v[52:55]
  ds_read_b64_tr_b16 v[174:175], v9 offset:36864
  v_mfma_f32_16x16x32_bf16 v[56:59], v[184:187], v[216:219], v[56:59]
  ds_read_b64_tr_b16 v[132:133], v3 offset:7168
  v_mfma_f32_16x16x32_bf16 v[60:63], v[184:187], v[220:223], v[60:63]
  ds_read_b64_tr_b16 v[134:135], v3 offset:10752
  v_mfma_f32_16x16x32_bf16 v[64:67], v[188:191], v[208:211], v[64:67]
  ds_read_b64_tr_b16 v[136:137], v3 offset:32
  v_mfma_f32_16x16x32_bf16 v[68:71], v[188:191], v[212:215], v[68:71]
  ds_read_b64_tr_b16 v[138:139], v3 offset:3616
  v_mfma_f32_16x16x32_bf16 v[72:75], v[188:191], v[216:219], v[72:75]
  ds_read_b64_tr_b16 v[140:141], v3 offset:7200
  v_mfma_f32_16x16x32_bf16 v[76:79], v[188:191], v[220:223], v[76:79]
  ds_read_b64_tr_b16 v[142:143], v3 offset:10784
  v_mfma_f32_16x16x32_bf16 v[80:83], v[192:195], v[208:211], v[80:83]
  ds_read_b64_tr_b16 v[144:145], v3 offset:64
  v_mfma_f32_16x16x32_bf16 v[84:87], v[192:195], v[212:215], v[84:87]
  ds_read_b64_tr_b16 v[146:147], v3 offset:3648
  v_mfma_f32_16x16x32_bf16 v[88:91], v[192:195], v[216:219], v[88:91]
  ds_read_b64_tr_b16 v[148:149], v3 offset:7232
  v_mfma_f32_16x16x32_bf16 v[92:95], v[192:195], v[220:223], v[92:95]
  ds_read_b64_tr_b16 v[150:151], v3 offset:10816
  v_mfma_f32_16x16x32_bf16 v[96:99], v[196:199], v[208:211], v[96:99]
  ds_read_b64_tr_b16 v[152:153], v5 offset:0
  v_mfma_f32_16x16x32_bf16 v[100:103], v[196:199], v[212:215], v[100:103]
  ds_read_b64_tr_b16 v[154:155], v5 offset:3584
  v_mfma_f32_16x16x32_bf16 v[104:107], v[196:199], v[216:219], v[104:107]
  ds_read_b64_tr_b16 v[156:157], v5 offset:7168
  v_mfma_f32_16x16x32_bf16 v[108:111], v[196:199], v[220:223], v[108:111]
  ds_read_b64_tr_b16 v[158:159], v5 offset:10752
  v_mfma_f32_16x16x32_bf16 v[112:115], v[200:203], v[208:211], v[112:115]
  v_mfma_f32_16x16x32_bf16 v[116:119], v[200:203], v[212:215], v[116:119]
  v_add_f32 v224, v237, v224
  v_fmac_f32 v225, v237, v237
  v_mfma_f32_16x16x32_bf16 v[120:123], v[204:207], v[208:211], v[120:123]
  v_add_f32 v228, v245, v228
  v_fmac_f32 v229, v245, v245
  v_mfma_f32_16x16x32_bf16 v[124:127], v[204:207], v[212:215], v[124:127]
  v_add_f32 v224, v238, v224
  v_fmac_f32 v225, v238, v238
  s_waitcnt lgkmcnt(0)
  v_mfma_f32_16x16x32_bf16 v[16:19], v[128:131], v[160:163], v[16:19]
  ds_read_b64_tr_b16 v[208:209], v6 offset:40960
  v_mfma_f32_16x16x32_bf16 v[20:23], v[128:131], v[164:167], v[20:23]
  ds_read_b64_tr_b16 v[210:211], v6 offset:45056
  v_mfma_f32_16x16x32_bf16 v[24:27], v[128:131], v[168:171], v[24:27]
  ds_read_b64_tr_b16 v[176:177], v3 offset:14336
  v_mfma_f32_16x16x32_bf16 v[28:31], v[128:131], v[172:175], v[28:31]
  v_add_f32 v228, v246, v228
  ds_read_b64_tr_b16 v[178:179], v3 offset:17920
  v_mfma_f32_16x16x32_bf16 v[32:35], v[132:135], v[160:163], v[32:35]
  ds_read_b64_tr_b16 v[212:213], v7 offset:40960
  v_mfma_f32_16x16x32_bf16 v[36:39], v[132:135], v[164:167], v[36:39]
  v_fmac_f32 v229, v246, v246
  ds_read_b64_tr_b16 v[214:215], v7 offset:45056
  v_mfma_f32_16x16x32_bf16 v[40:43], v[132:135], v[168:171], v[40:43]
  ds_read_b64_tr_b16 v[216:217], v8 offset:40960
  v_mfma_f32_16x16x32_bf16 v[44:47], v[132:135], v[172:175], v[44:47]
  ds_read_b64_tr_b16 v[218:219], v8 offset:45056
  v_mfma_f32_16x16x32_bf16 v[48:51], v[136:139], v[160:163], v[48:51]
  ds_read_b64_tr_b16 v[220:221], v9 offset:40960
  v_mfma_f32_16x16x32_bf16 v[52:55], v[136:139], v[164:167], v[52:55]
  ds_read_b64_tr_b16 v[222:223], v9 offset:45056
  v_mfma_f32_16x16x32_bf16 v[56:59], v[136:139], v[168:171], v[56:59]
  ds_read_b64_tr_b16 v[180:181], v3 offset:21504
  v_mfma_f32_16x16x32_bf16 v[60:63], v[136:139], v[172:175], v[60:63]
  ds_read_b64_tr_b16 v[182:183], v3 offset:25088
  v_mfma_f32_16x16x32_bf16 v[64:67], v[140:143], v[160:163], v[64:67]
  ds_read_b64_tr_b16 v[184:185], v3 offset:14368
  v_mfma_f32_16x16x32_bf16 v[68:71], v[140:143], v[164:167], v[68:71]
  ds_read_b64_tr_b16 v[186:187], v3 offset:17952
  v_mfma_f32_16x16x32_bf16 v[72:75], v[140:143], v[168:171], v[72:75]
  ds_read_b64_tr_b16 v[188:189], v3 offset:21536
  v_mfma_f32_16x16x32_bf16 v[76:79], v[140:143], v[172:175], v[76:79]
  ds_read_b64_tr_b16 v[190:191], v3 offset:25120
  v_mfma_f32_16x16x32_bf16 v[80:83], v[144:147], v[160:163], v[80:83]
  ds_read_b64_tr_b16 v[192:193], v3 offset:14400
  v_mfma_f32_16x16x32_bf16 v[84:87], v[144:147], v[164:167], v[84:87]
  ds_read_b64_tr_b16 v[194:195], v3 offset:17984
  v_mfma_f32_16x16x32_bf16 v[88:91], v[144:147], v[168:171], v[88:91]
  ds_read_b64_tr_b16 v[196:197], v3 offset:21568
  v_mfma_f32_16x16x32_bf16 v[92:95], v[144:147], v[172:175], v[92:95]
  ds_read_b64_tr_b16 v[198:199], v3 offset:25152
  v_mfma_f32_16x16x32_bf16 v[96:99], v[148:151], v[160:163], v[96:99]
  ds_read_b64_tr_b16 v[200:201], v5 offset:14336
  v_mfma_f32_16x16x32_bf16 v[100:103], v[148:151], v[164:167], v[100:103]
  ds_read_b64_tr_b16 v[202:203], v5 offset:17920
  v_mfma_f32_16x16x32_bf16 v[104:107], v[148:151], v[168:171], v[104:107]
  ds_read_b64_tr_b16 v[204:205], v5 offset:21504
  v_mfma_f32_16x16x32_bf16 v[108:111], v[148:151], v[172:175], v[108:111]
  ds_read_b64_tr_b16 v[206:207], v5 offset:25088
  v_mfma_f32_16x16x32_bf16 v[112:115], v[152:155], v[160:163], v[112:115]
  v_mfma_f32_16x16x32_bf16 v[116:119], v[152:155], v[164:167], v[116:119]
  v_add_f32 v224, v239, v224
  v_fmac_f32 v225, v239, v239
  v_mfma_f32_16x16x32_bf16 v[120:123], v[156:159], v[160:163], v[120:123]
  v_add_f32 v228, v247, v228
  v_fmac_f32 v229, v247, v247
  v_mfma_f32_16x16x32_bf16 v[124:127], v[156:159], v[164:167], v[124:127]
  v_permlane32_swap_b32 v224, v228
  v_permlane32_swap_b32 v225, v229
  s_waitcnt lgkmcnt(0)
  s_barrier
  v_mfma_f32_16x16x32_bf16 v[16:19], v[176:179], v[208:211], v[16:19]
  ds_read_b64_tr_b16 v[160:161], v6 offset:49152
  v_mfma_f32_16x16x32_bf16 v[20:23], v[176:179], v[212:215], v[20:23]
  ds_read_b64_tr_b16 v[162:163], v6 offset:53248
  v_mfma_f32_16x16x32_bf16 v[24:27], v[176:179], v[216:219], v[24:27]
  ds_read_b64_tr_b16 v[128:129], v3 offset:28672
  v_mfma_f32_16x16x32_bf16 v[28:31], v[176:179], v[220:223], v[28:31]
  v_add_f32 v224, v224, v228
  ds_read_b64_tr_b16 v[130:131], v3 offset:32256
  v_mfma_f32_16x16x32_bf16 v[32:35], v[180:183], v[208:211], v[32:35]
  ds_read_b64_tr_b16 v[164:165], v7 offset:49152
  v_mfma_f32_16x16x32_bf16 v[36:39], v[180:183], v[212:215], v[36:39]
  ds_read_b64_tr_b16 v[166:167], v7 offset:53248
  v_mfma_f32_16x16x32_bf16 v[40:43], v[180:183], v[216:219], v[40:43]
  v_add_f32 v225, v225, v229
  ds_read_b64_tr_b16 v[168:169], v8 offset:49152
  v_mfma_f32_16x16x32_bf16 v[44:47], v[180:183], v[220:223], v[44:47]
  ds_read_b64_tr_b16 v[170:171], v8 offset:53248
  v_mfma_f32_16x16x32_bf16 v[48:51], v[184:187], v[208:211], v[48:51]
  ds_read_b64_tr_b16 v[172:173], v9 offset:49152
  v_mfma_f32_16x16x32_bf16 v[52:55], v[184:187], v[212:215], v[52:55]
  v_mov_b32 v228, v224
  ds_read_b64_tr_b16 v[174:175], v9 offset:53248
  v_mfma_f32_16x16x32_bf16 v[56:59], v[184:187], v[216:219], v[56:59]
  ds_read_b64_tr_b16 v[132:133], v3 offset:35840
  v_mfma_f32_16x16x32_bf16 v[60:63], v[184:187], v[220:223], v[60:63]
  ds_read_b64_tr_b16 v[134:135], v3 offset:39424
  v_mfma_f32_16x16x32_bf16 v[64:67], v[188:191], v[208:211], v[64:67]
  v_mov_b32 v229, v225
  ds_read_b64_tr_b16 v[136:137], v3 offset:28704
  v_mfma_f32_16x16x32_bf16 v[68:71], v[188:191], v[212:215], v[68:71]
  ds_read_b64_tr_b16 v[138:139], v3 offset:32288
  v_mfma_f32_16x16x32_bf16 v[72:75], v[188:191], v[216:219], v[72:75]
  ds_read_b64_tr_b16 v[140:141], v3 offset:35872
  v_mfma_f32_16x16x32_bf16 v[76:79], v[188:191], v[220:223], v[76:79]
  v_permlane16_swap_b32 v224, v228
  ds_read_b64_tr_b16 v[142:143], v3 offset:39456
  v_mfma_f32_16x16x32_bf16 v[80:83], v[192:195], v[208:211], v[80:83]
  ds_read_b64_tr_b16 v[144:145], v3 offset:28736
  v_mfma_f32_16x16x32_bf16 v[84:87], v[192:195], v[212:215], v[84:87]
  ds_read_b64_tr_b16 v[146:147], v3 offset:32320
  v_mfma_f32_16x16x32_bf16 v[88:91], v[192:195], v[216:219], v[88:91]
  v_permlane16_swap_b32 v225, v229
  ds_read_b64_tr_b16 v[148:149], v3 offset:35904
  v_mfma_f32_16x16x32_bf16 v[92:95], v[192:195], v[220:223], v[92:95]
  ds_read_b64_tr_b16 v[150:151], v3 offset:39488
  v_mfma_f32_16x16x32_bf16 v[96:99], v[196:199], v[208:211], v[96:99]
  ds_read_b64_tr_b16 v[152:153], v5 offset:28672
  v_mfma_f32_16x16x32_bf16 v[100:103], v[196:199], v[212:215], v[100:103]
  v_add_f32 v224, v224, v228
  ds_read_b64_tr_b16 v[154:155], v5 offset:32256
  v_mfma_f32_16x16x32_bf16 v[104:107], v[196:199], v[216:219], v[104:107]
  ds_read_b64_tr_b16 v[156:157], v5 offset:35840
  v_mfma_f32_16x16x32_bf16 v[108:111], v[196:199], v[220:223], v[108:111]
  ds_read_b64_tr_b16 v[158:159], v5 offset:39424
  v_mfma_f32_16x16x32_bf16 v[112:115], v[200:203], v[208:211], v[112:115]
  v_add_f32 v225, v225, v229
  v_mfma_f32_16x16x32_bf16 v[116:119], v[200:203], v[212:215], v[116:119]
  v_mfma_f32_16x16x32_bf16 v[120:123], v[204:207], v[208:211], v[120:123]
  v_mfma_f32_16x16x32_bf16 v[124:127], v[204:207], v[212:215], v[124:127]
  s_waitcnt lgkmcnt(0)
  v_mfma_f32_16x16x32_bf16 v[16:19], v[128:131], v[160:163], v[16:19]
  ds_read_b64_tr_b16 v[208:209], v6 offset:0
  v_mfma_f32_16x16x32_bf16 v[20:23], v[128:131], v[164:167], v[20:23]
  ds_read_b64_tr_b16 v[210:211], v6 offset:4096
  v_mfma_f32_16x16x32_bf16 v[24:27], v[128:131], v[168:171], v[24:27]
  ds_read_b64_tr_b16 v[176:177], v2 offset:0
  v_mfma_f32_16x16x32_bf16 v[28:31], v[128:131], v[172:175], v[28:31]
  buffer_store_dwordx4 v[224:227], v14, s[44:47], s12 offen sc1
  ds_read_b64_tr_b16 v[178:179], v2 offset:3584
  v_mfma_f32_16x16x32_bf16 v[32:35], v[132:135], v[160:163], v[32:35]
  ds_read_b64_tr_b16 v[212:213], v7 offset:0
  v_mfma_f32_16x16x32_bf16 v[36:39], v[132:135], v[164:167], v[36:39]
  ds_read_b64_tr_b16 v[214:215], v7 offset:4096
  v_mfma_f32_16x16x32_bf16 v[40:43], v[132:135], v[168:171], v[40:43]
  ds_read_b64_tr_b16 v[216:217], v8 offset:0
  v_mfma_f32_16x16x32_bf16 v[44:47], v[132:135], v[172:175], v[44:47]
  ds_read_b64_tr_b16 v[218:219], v8 offset:4096
  v_mfma_f32_16x16x32_bf16 v[48:51], v[136:139], v[160:163], v[48:51]
  ds_read_b64_tr_b16 v[220:221], v9 offset:0
  v_mfma_f32_16x16x32_bf16 v[52:55], v[136:139], v[164:167], v[52:55]
  ds_read_b64_tr_b16 v[222:223], v9 offset:4096
  v_mfma_f32_16x16x32_bf16 v[56:59], v[136:139], v[168:171], v[56:59]
  ds_read_b64_tr_b16 v[180:181], v2 offset:7168
  v_mfma_f32_16x16x32_bf16 v[60:63], v[136:139], v[172:175], v[60:63]
  ds_read_b64_tr_b16 v[182:183], v2 offset:10752
  v_mfma_f32_16x16x32_bf16 v[64:67], v[140:143], v[160:163], v[64:67]
  ds_read_b64_tr_b16 v[184:185], v2 offset:32
  v_mfma_f32_16x16x32_bf16 v[68:71], v[140:143], v[164:167], v[68:71]
  ds_read_b64_tr_b16 v[186:187], v2 offset:3616
  v_mfma_f32_16x16x32_bf16 v[72:75], v[140:143], v[168:171], v[72:75]
  ds_read_b64_tr_b16 v[188:189], v2 offset:7200
  v_mfma_f32_16x16x32_bf16 v[76:79], v[140:143], v[172:175], v[76:79]
  ds_read_b64_tr_b16 v[190:191], v2 offset:10784
  v_mfma_f32_16x16x32_bf16 v[80:83], v[144:147], v[160:163], v[80:83]
  ds_read_b64_tr_b16 v[192:193], v2 offset:64
  v_mfma_f32_16x16x32_bf16 v[84:87], v[144:147], v[164:167], v[84:87]
  ds_read_b64_tr_b16 v[194:195], v2 offset:3648
  v_mfma_f32_16x16x32_bf16 v[88:91], v[144:147], v[168:171], v[88:91]
  ds_read_b64_tr_b16 v[196:197], v2 offset:7232
  v_mfma_f32_16x16x32_bf16 v[92:95], v[144:147], v[172:175], v[92:95]
  ds_read_b64_tr_b16 v[198:199], v2 offset:10816
  v_mfma_f32_16x16x32_bf16 v[96:99], v[148:151], v[160:163], v[96:99]
  ds_read_b64_tr_b16 v[200:201], v4 offset:0
  v_mfma_f32_16x16x32_bf16 v[100:103], v[148:151], v[164:167], v[100:103]
  ds_read_b64_tr_b16 v[202:203], v4 offset:3584
  v_mfma_f32_16x16x32_bf16 v[104:107], v[148:151], v[168:171], v[104:107]
  ds_read_b64_tr_b16 v[204:205], v4 offset:7168
  v_mfma_f32_16x16x32_bf16 v[108:111], v[148:151], v[172:175], v[108:111]
  ds_read_b64_tr_b16 v[206:207], v4 offset:10752
  v_mfma_f32_16x16x32_bf16 v[112:115], v[152:155], v[160:163], v[112:115]
  v_mfma_f32_16x16x32_bf16 v[116:119], v[152:155], v[164:167], v[116:119]
  v_mfma_f32_16x16x32_bf16 v[120:123], v[156:159], v[160:163], v[120:123]
  v_mfma_f32_16x16x32_bf16 v[124:127], v[156:159], v[164:167], v[124:127]
  s_waitcnt lgkmcnt(0)
  s_barrier
  v_mfma_f32_16x16x32_bf16 v[16:19], v[176:179], v[208:211], v[16:19]
  ds_read_b64_tr_b16 v[160:161], v6 offset:8192
  v_mfma_f32_16x16x32_bf16 v[20:23], v[176:179], v[212:215], v[20:23]
  ds_read_b64_tr_b16 v[162:163], v6 offset:12288
  v_mfma_f32_16x16x32_bf16 v[24:27], v[176:179], v[216:219], v[24:27]
  ds_read_b64_tr_b16 v[128:129], v2 offset:14336
  v_mfma_f32_16x16x32_bf16 v[28:31], v[176:179], v[220:223], v[28:31]
  ds_read_b64_tr_b16 v[130:131], v2 offset:17920
  v_mfma_f32_16x16x32_bf16 v[32:35], v[180:183], v[208:211], v[32:35]
  ds_read_b64_tr_b16 v[164:165], v7 offset:8192
  v_mfma_f32_16x16x32_bf16 v[36:39], v[180:183], v[212:215], v[36:39]
  ds_read_b64_tr_b16 v[166:167], v7 offset:12288
  v_mfma_f32_16x16x32_bf16 v[40:43], v[180:183], v[216:219], v[40:43]
  ds_read_b64_tr_b16 v[168:169], v8 offset:8192
  v_mfma_f32_16x16x32_bf16 v[44:47], v[180:183], v[220:223], v[44:47]
  ds_read_b64_tr_b16 v[170:171], v8 offset:12288
  v_mfma_f32_16x16x32_bf16 v[48:51], v[184:187], v[208:211], v[48:51]
  ds_read_b64_tr_b16 v[172:173], v9 offset:8192
  v_mfma_f32_16x16x32_bf16 v[52:55], v[184:187], v[212:215], v[52:55]
  ds_read_b64_tr_b16 v[174:175], v9 offset:12288
  v_mfma_f32_16x16x32_bf16 v[56:59], v[184:187], v[216:219], v[56:59]
  ds_read_b64_tr_b16 v[132:133], v2 offset:21504
  v_mfma_f32_16x16x32_bf16 v[60:63], v[184:187], v[220:223], v[60:63]
  ds_read_b64_tr_b16 v[134:135], v2 offset:25088
  v_mfma_f32_16x16x32_bf16 v[64:67], v[188:191], v[208:211], v[64:67]
  ds_read_b64_tr_b16 v[136:137], v2 offset:14368
  v_mfma_f32_16x16x32_bf16 v[68:71], v[188:191], v[212:215], v[68:71]
  ds_read_b64_tr_b16 v[138:139], v2 offset:17952
  v_mfma_f32_16x16x32_bf16 v[72:75], v[188:191], v[216:219], v[72:75]
  ds_read_b64_tr_b16 v[140:141], v2 offset:21536
  v_mfma_f32_16x16x32_bf16 v[76:79], v[188:191], v[220:223], v[76:79]
  ds_read_b64_tr_b16 v[142:143], v2 offset:25120
  v_mfma_f32_16x16x32_bf16 v[80:83], v[192:195], v[208:211], v[80:83]
  ds_read_b64_tr_b16 v[144:145], v2 offset:14400
  v_mfma_f32_16x16x32_bf16 v[84:87], v[192:195], v[212:215], v[84:87]
  ds_read_b64_tr_b16 v[146:147], v2 offset:17984
  v_mfma_f32_16x16x32_bf16 v[88:91], v[192:195], v[216:219], v[88:91]
  ds_read_b64_tr_b16 v[148:149], v2 offset:21568
  v_mfma_f32_16x16x32_bf16 v[92:95], v[192:195], v[220:223], v[92:95]
  ds_read_b64_tr_b16 v[150:151], v2 offset:25152
  v_mfma_f32_16x16x32_bf16 v[96:99], v[196:199], v[208:211], v[96:99]
  ds_read_b64_tr_b16 v[152:153], v4 offset:14336
  v_mfma_f32_16x16x32_bf16 v[100:103], v[196:199], v[212:215], v[100:103]
  ds_read_b64_tr_b16 v[154:155], v4 offset:17920
  v_mfma_f32_16x16x32_bf16 v[104:107], v[196:199], v[216:219], v[104:107]
  ds_read_b64_tr_b16 v[156:157], v4 offset:21504
  v_mfma_f32_16x16x32_bf16 v[108:111], v[196:199], v[220:223], v[108:111]
  ds_read_b64_tr_b16 v[158:159], v4 offset:25088
  v_mfma_f32_16x16x32_bf16 v[112:115], v[200:203], v[208:211], v[112:115]
  v_mfma_f32_16x16x32_bf16 v[116:119], v[200:203], v[212:215], v[116:119]
  v_mfma_f32_16x16x32_bf16 v[120:123], v[204:207], v[208:211], v[120:123]
  v_mfma_f32_16x16x32_bf16 v[124:127], v[204:207], v[212:215], v[124:127]
  s_waitcnt lgkmcnt(0)
  v_mfma_f32_16x16x32_bf16 v[16:19], v[128:131], v[160:163], v[16:19]
  ds_read_b64_tr_b16 v[208:209], v6 offset:16384
  v_mfma_f32_16x16x32_bf16 v[20:23], v[128:131], v[164:167], v[20:23]
  ds_read_b64_tr_b16 v[210:211], v6 offset:20480
  v_mfma_f32_16x16x32_bf16 v[24:27], v[128:131], v[168:171], v[24:27]
  ds_read_b64_tr_b16 v[176:177], v2 offset:28672
  v_mfma_f32_16x16x32_bf16 v[28:31], v[128:131], v[172:175], v[28:31]
  ds_read_b64_tr_b16 v[178:179], v2 offset:32256
  v_mfma_f32_16x16x32_bf16 v[32:35], v[132:135], v[160:163], v[32:35]
  ds_read_b64_tr_b16 v[212:213], v7 offset:16384
  v_mfma_f32_16x16x32_bf16 v[36:39], v[132:135], v[164:167], v[36:39]
  ds_read_b64_tr_b16 v[214:215], v7 offset:20480
  v_mfma_f32_16x16x32_bf16 v[40:43], v[132:135], v[168:171], v[40:43]
  ds_read_b64_tr_b16 v[216:217], v8 offset:16384
  v_mfma_f32_16x16x32_bf16 v[44:47], v[132:135], v[172:175], v[44:47]
  ds_read_b64_tr_b16 v[218:219], v8 offset:20480
  v_mfma_f32_16x16x32_bf16 v[48:51], v[136:139], v[160:163], v[48:51]
  ds_read_b64_tr_b16 v[220:221], v9 offset:16384
  v_mfma_f32_16x16x32_bf16 v[52:55], v[136:139], v[164:167], v[52:55]
  ds_read_b64_tr_b16 v[222:223], v9 offset:20480
  v_mfma_f32_16x16x32_bf16 v[56:59], v[136:139], v[168:171], v[56:59]
  ds_read_b64_tr_b16 v[180:181], v2 offset:35840
  v_mfma_f32_16x16x32_bf16 v[60:63], v[136:139], v[172:175], v[60:63]
  ds_read_b64_tr_b16 v[182:183], v2 offset:39424
  v_mfma_f32_16x16x32_bf16 v[64:67], v[140:143], v[160:163], v[64:67]
  ds_read_b64_tr_b16 v[184:185], v2 offset:28704
  v_mfma_f32_16x16x32_bf16 v[68:71], v[140:143], v[164:167], v[68:71]
  ds_read_b64_tr_b16 v[186:187], v2 offset:32288
  v_mfma_f32_16x16x32_bf16 v[72:75], v[140:143], v[168:171], v[72:75]
  ds_read_b64_tr_b16 v[188:189], v2 offset:35872
  v_mfma_f32_16x16x32_bf16 v[76:79], v[140:143], v[172:175], v[76:79]
  ds_read_b64_tr_b16 v[190:191], v2 offset:39456
  v_mfma_f32_16x16x32_bf16 v[80:83], v[144:147], v[160:163], v[80:83]
  ds_read_b64_tr_b16 v[192:193], v2 offset:28736
  v_mfma_f32_16x16x32_bf16 v[84:87], v[144:147], v[164:167], v[84:87]
  ds_read_b64_tr_b16 v[194:195], v2 offset:32320
  v_mfma_f32_16x16x32_bf16 v[88:91], v[144:147], v[168:171], v[88:91]
  ds_read_b64_tr_b16 v[196:197], v2 offset:35904
  v_mfma_f32_16x16x32_bf16 v[92:95], v[144:147], v[172:175], v[92:95]
  ds_read_b64_tr_b16 v[198:199], v2 offset:39488
  v_mfma_f32_16x16x32_bf16 v[96:99], v[148:151], v[160:163], v[96:99]
  ds_read_b64_tr_b16 v[200:201], v4 offset:28672
  v_mfma_f32_16x16x32_bf16 v[100:103], v[148:151], v[164:167], v[100:103]
  ds_read_b64_tr_b16 v[202:203], v4 offset:32256
  v_mfma_f32_16x16x32_bf16 v[104:107], v[148:151], v[168:171], v[104:107]
  ds_read_b64_tr_b16 v[204:205], v4 offset:35840
  v_mfma_f32_16x16x32_bf16 v[108:111], v[148:151], v[172:175], v[108:111]
  ds_read_b64_tr_b16 v[206:207], v4 offset:39424
  v_mfma_f32_16x16x32_bf16 v[112:115], v[152:155], v[160:163], v[112:115]
  v_mfma_f32_16x16x32_bf16 v[116:119], v[152:155], v[164:167], v[116:119]
  v_mfma_f32_16x16x32_bf16 v[120:123], v[156:159], v[160:163], v[120:123]
  v_mfma_f32_16x16x32_bf16 v[124:127], v[156:159], v[164:167], v[124:127]
  s_waitcnt lgkmcnt(0)
  s_barrier
  v_mfma_f32_16x16x32_bf16 v[16:19], v[176:179], v[208:211], v[16:19]
  ds_read_b64_tr_b16 v[160:161], v6 offset:24576
  v_mfma_f32_16x16x32_bf16 v[20:23], v[176:179], v[212:215], v[20:23]
  ds_read_b64_tr_b16 v[162:163], v6 offset:28672
  v_mfma_f32_16x16x32_bf16 v[24:27], v[176:179], v[216:219], v[24:27]
  ds_read_b64_tr_b16 v[128:129], v2 offset:43008
  v_mfma_f32_16x16x32_bf16 v[28:31], v[176:179], v[220:223], v[28:31]
  ds_read_b64_tr_b16 v[130:131], v2 offset:46592
  v_mfma_f32_16x16x32_bf16 v[32:35], v[180:183], v[208:211], v[32:35]
  ds_read_b64_tr_b16 v[164:165], v7 offset:24576
  v_mfma_f32_16x16x32_bf16 v[36:39], v[180:183], v[212:215], v[36:39]
  ds_read_b64_tr_b16 v[166:167], v7 offset:28672
  v_mfma_f32_16x16x32_bf16 v[40:43], v[180:183], v[216:219], v[40:43]
  ds_read_b64_tr_b16 v[168:169], v8 offset:24576
  v_mfma_f32_16x16x32_bf16 v[44:47], v[180:183], v[220:223], v[44:47]
  ds_read_b64_tr_b16 v[170:171], v8 offset:28672
  v_mfma_f32_16x16x32_bf16 v[48:51], v[184:187], v[208:211], v[48:51]
  ds_read_b64_tr_b16 v[172:173], v9 offset:24576
  v_mfma_f32_16x16x32_bf16 v[52:55], v[184:187], v[212:215], v[52:55]
  ds_read_b64_tr_b16 v[174:175], v9 offset:28672
  v_mfma_f32_16x16x32_bf16 v[56:59], v[184:187], v[216:219], v[56:59]
  ds_read_b64_tr_b16 v[132:133], v2 offset:50176
  v_mfma_f32_16x16x32_bf16 v[60:63], v[184:187], v[220:223], v[60:63]
  ds_read_b64_tr_b16 v[134:135], v2 offset:53760
  v_mfma_f32_16x16x32_bf16 v[64:67], v[188:191], v[208:211], v[64:67]
  ds_read_b64_tr_b16 v[136:137], v2 offset:43040
  v_mfma_f32_16x16x32_bf16 v[68:71], v[188:191], v[212:215], v[68:71]
  ds_read_b64_tr_b16 v[138:139], v2 offset:46624
  v_mfma_f32_16x16x32_bf16 v[72:75], v[188:191], v[216:219], v[72:75]
  ds_read_b64_tr_b16 v[140:141], v2 offset:50208
  v_mfma_f32_16x16x32_bf16 v[76:79], v[188:191], v[220:223], v[76:79]
  ds_read_b64_tr_b16 v[142:143], v2 offset:53792
  v_mfma_f32_16x16x32_bf16 v[80:83], v[192:195], v[208:211], v[80:83]
  ds_read_b64_tr_b16 v[144:145], v2 offset:43072
  v_mfma_f32_16x16x32_bf16 v[84:87], v[192:195], v[212:215], v[84:87]
  ds_read_b64_tr_b16 v[146:147], v2 offset:46656
  v_mfma_f32_16x16x32_bf16 v[88:91], v[192:195], v[216:219], v[88:91]
  ds_read_b64_tr_b16 v[148:149], v2 offset:50240
  v_mfma_f32_16x16x32_bf16 v[92:95], v[192:195], v[220:223], v[92:95]
  ds_read_b64_tr_b16 v[150:151], v2 offset:53824
  v_mfma_f32_16x16x32_bf16 v[96:99], v[196:199], v[208:211], v[96:99]
  ds_read_b64_tr_b16 v[152:153], v4 offset:43008
  v_mfma_f32_16x16x32_bf16 v[100:103], v[196:199], v[212:215], v[100:103]
  ds_read_b64_tr_b16 v[154:155], v4 offset:46592
  v_mfma_f32_16x16x32_bf16 v[104:107], v[196:199], v[216:219], v[104:107]
  ds_read_b64_tr_b16 v[156:157], v4 offset:50176
  v_mfma_f32_16x16x32_bf16 v[108:111], v[196:199], v[220:223], v[108:111]
  ds_read_b64_tr_b16 v[158:159], v4 offset:53760
  v_mfma_f32_16x16x32_bf16 v[112:115], v[200:203], v[208:211], v[112:115]
  v_mfma_f32_16x16x32_bf16 v[116:119], v[200:203], v[212:215], v[116:119]
  v_mfma_f32_16x16x32_bf16 v[120:123], v[204:207], v[208:211], v[120:123]
  v_mfma_f32_16x16x32_bf16 v[124:127], v[204:207], v[212:215], v[124:127]
  s_waitcnt lgkmcnt(0)
  v_mfma_f32_16x16x32_bf16 v[16:19], v[128:131], v[160:163], v[16:19]
  ds_read_b64_tr_b16 v[208:209], v6 offset:32768
  v_mfma_f32_16x16x32_bf16 v[20:23], v[128:131], v[164:167], v[20:23]
  ds_read_b64_tr_b16 v[210:211], v6 offset:36864
  v_mfma_f32_16x16x32_bf16 v[24:27], v[128:131], v[168:171], v[24:27]
  ds_read_b64_tr_b16 v[176:177], v3 offset:0
  v_mfma_f32_16x16x32_bf16 v[28:31], v[128:131], v[172:175], v[28:31]
  ds_read_b64_tr_b16 v[178:179], v3 offset:3584
  v_mfma_f32_16x16x32_bf16 v[32:35], v[132:135], v[160:163], v[32:35]
  ds_read_b64_tr_b16 v[212:213], v7 offset:32768
  v_mfma_f32_16x16x32_bf16 v[36:39], v[132:135], v[164:167], v[36:39]
  ds_read_b64_tr_b16 v[214:215], v7 offset:36864
  v_mfma_f32_16x16x32_bf16 v[40:43], v[132:135], v[168:171], v[40:43]
  ds_read_b64_tr_b16 v[216:217], v8 offset:32768
  v_mfma_f32_16x16x32_bf16 v[44:47], v[132:135], v[172:175], v[44:47]
  ds_read_b64_tr_b16 v[218:219], v8 offset:36864
  v_mfma_f32_16x16x32_bf16 v[48:51], v[136:139], v[160:163], v[48:51]
  ds_read_b64_tr_b16 v[220:221], v9 offset:32768
  v_mfma_f32_16x16x32_bf16 v[52:55], v[136:139], v[164:167], v[52:55]
  ds_read_b64_tr_b16 v[222:223], v9 offset:36864
  v_mfma_f32_16x16x32_bf16 v[56:59], v[136:139], v[168:171], v[56:59]
  ds_read_b64_tr_b16 v[180:181], v3 offset:7168
  v_mfma_f32_16x16x32_bf16 v[60:63], v[136:139], v[172:175], v[60:63]
  ds_read_b64_tr_b16 v[182:183], v3 offset:10752
  v_mfma_f32_16x16x32_bf16 v[64:67], v[140:143], v[160:163], v[64:67]
  ds_read_b64_tr_b16 v[184:185], v3 offset:32
  v_mfma_f32_16x16x32_bf16 v[68:71], v[140:143], v[164:167], v[68:71]
  ds_read_b64_tr_b16 v[186:187], v3 offset:3616
  v_mfma_f32_16x16x32_bf16 v[72:75], v[140:143], v[168:171], v[72:75]
  ds_read_b64_tr_b16 v[188:189], v3 offset:7200
  v_mfma_f32_16x16x32_bf16 v[76:79], v[140:143], v[172:175], v[76:79]
  ds_read_b64_tr_b16 v[190:191], v3 offset:10784
  v_mfma_f32_16x16x32_bf16 v[80:83], v[144:147], v[160:163], v[80:83]
  ds_read_b64_tr_b16 v[192:193], v3 offset:64
  v_mfma_f32_16x16x32_bf16 v[84:87], v[144:147], v[164:167], v[84:87]
  ds_read_b64_tr_b16 v[194:195], v3 offset:3648
  v_mfma_f32_16x16x32_bf16 v[88:91], v[144:147], v[168:171], v[88:91]
  ds_read_b64_tr_b16 v[196:197], v3 offset:7232
  v_mfma_f32_16x16x32_bf16 v[92:95], v[144:147], v[172:175], v[92:95]
  ds_read_b64_tr_b16 v[198:199], v3 offset:10816
  v_mfma_f32_16x16x32_bf16 v[96:99], v[148:151], v[160:163], v[96:99]
  ds_read_b64_tr_b16 v[200:201], v5 offset:0
  v_mfma_f32_16x16x32_bf16 v[100:103], v[148:151], v[164:167], v[100:103]
  ds_read_b64_tr_b16 v[202:203], v5 offset:3584
  v_mfma_f32_16x16x32_bf16 v[104:107], v[148:151], v[168:171], v[104:107]
  ds_read_b64_tr_b16 v[204:205], v5 offset:7168
  v_mfma_f32_16x16x32_bf16 v[108:111], v[148:151], v[172:175], v[108:111]
  ds_read_b64_tr_b16 v[206:207], v5 offset:10752
  v_mfma_f32_16x16x32_bf16 v[112:115], v[152:155], v[160:163], v[112:115]
  v_mfma_f32_16x16x32_bf16 v[116:119], v[152:155], v[164:167], v[116:119]
  v_mfma_f32_16x16x32_bf16 v[120:123], v[156:159], v[160:163], v[120:123]
  v_mfma_f32_16x16x32_bf16 v[124:127], v[156:159], v[164:167], v[124:127]
  s_waitcnt lgkmcnt(0)
  s_barrier
  v_mfma_f32_16x16x32_bf16 v[16:19], v[176:179], v[208:211], v[16:19]
  ds_read_b64_tr_b16 v[160:161], v6 offset:40960
  v_mfma_f32_16x16x32_bf16 v[20:23], v[176:179], v[212:215], v[20:23]
  ds_read_b64_tr_b16 v[162:163], v6 offset:45056
  v_mfma_f32_16x16x32_bf16 v[24:27], v[176:179], v[216:219], v[24:27]
  ds_read_b64_tr_b16 v[128:129], v3 offset:14336
  v_mfma_f32_16x16x32_bf16 v[28:31], v[176:179], v[220:223], v[28:31]
  ds_read_b64_tr_b16 v[130:131], v3 offset:17920
  v_mfma_f32_16x16x32_bf16 v[32:35], v[180:183], v[208:211], v[32:35]
  ds_read_b64_tr_b16 v[164:165], v7 offset:40960
  v_mfma_f32_16x16x32_bf16 v[36:39], v[180:183], v[212:215], v[36:39]
  ds_read_b64_tr_b16 v[166:167], v7 offset:45056
  v_mfma_f32_16x16x32_bf16 v[40:43], v[180:183], v[216:219], v[40:43]
  ds_read_b64_tr_b16 v[168:169], v8 offset:40960
  v_mfma_f32_16x16x32_bf16 v[44:47], v[180:183], v[220:223], v[44:47]
  ds_read_b64_tr_b16 v[170:171], v8 offset:45056
  v_mfma_f32_16x16x32_bf16 v[48:51], v[184:187], v[208:211], v[48:51]
  ds_read_b64_tr_b16 v[172:173], v9 offset:40960
  v_mfma_f32_16x16x32_bf16 v[52:55], v[184:187], v[212:215], v[52:55]
  ds_read_b64_tr_b16 v[174:175], v9 offset:45056
  v_mfma_f32_16x16x32_bf16 v[56:59], v[184:187], v[216:219], v[56:59]
  ds_read_b64_tr_b16 v[132:133], v3 offset:21504
  v_mfma_f32_16x16x32_bf16 v[60:63], v[184:187], v[220:223], v[60:63]
  ds_read_b64_tr_b16 v[134:135], v3 offset:25088
  v_mfma_f32_16x16x32_bf16 v[64:67], v[188:191], v[208:211], v[64:67]
  ds_read_b64_tr_b16 v[136:137], v3 offset:14368
  v_mfma_f32_16x16x32_bf16 v[68:71], v[188:191], v[212:215], v[68:71]
  ds_read_b64_tr_b16 v[138:139], v3 offset:17952
  v_mfma_f32_16x16x32_bf16 v[72:75], v[188:191], v[216:219], v[72:75]
  ds_read_b64_tr_b16 v[140:141], v3 offset:21536
  v_mfma_f32_16x16x32_bf16 v[76:79], v[188:191], v[220:223], v[76:79]
  ds_read_b64_tr_b16 v[142:143], v3 offset:25120
  v_mfma_f32_16x16x32_bf16 v[80:83], v[192:195], v[208:211], v[80:83]
  ds_read_b64_tr_b16 v[144:145], v3 offset:14400
  v_mfma_f32_16x16x32_bf16 v[84:87], v[192:195], v[212:215], v[84:87]
  ds_read_b64_tr_b16 v[146:147], v3 offset:17984
  v_mfma_f32_16x16x32_bf16 v[88:91], v[192:195], v[216:219], v[88:91]
  ds_read_b64_tr_b16 v[148:149], v3 offset:21568
  v_mfma_f32_16x16x32_bf16 v[92:95], v[192:195], v[220:223], v[92:95]
  ds_read_b64_tr_b16 v[150:151], v3 offset:25152
  v_mfma_f32_16x16x32_bf16 v[96:99], v[196:199], v[208:211], v[96:99]
  ds_read_b64_tr_b16 v[152:153], v5 offset:14336
  v_mfma_f32_16x16x32_bf16 v[100:103], v[196:199], v[212:215], v[100:103]
  ds_read_b64_tr_b16 v[154:155], v5 offset:17920
  v_mfma_f32_16x16x32_bf16 v[104:107], v[196:199], v[216:219], v[104:107]
  ds_read_b64_tr_b16 v[156:157], v5 offset:21504
  v_mfma_f32_16x16x32_bf16 v[108:111], v[196:199], v[220:223], v[108:111]
  ds_read_b64_tr_b16 v[158:159], v5 offset:25088
  v_mfma_f32_16x16x32_bf16 v[112:115], v[200:203], v[208:211], v[112:115]
  v_mfma_f32_16x16x32_bf16 v[116:119], v[200:203], v[212:215], v[116:119]
  v_mfma_f32_16x16x32_bf16 v[120:123], v[204:207], v[208:211], v[120:123]
  v_mfma_f32_16x16x32_bf16 v[124:127], v[204:207], v[212:215], v[124:127]
  s_waitcnt lgkmcnt(0)
  v_mfma_f32_16x16x32_bf16 v[16:19], v[128:131], v[160:163], v[16:19]
  ds_read_b64_tr_b16 v[208:209], v6 offset:49152
  v_mfma_f32_16x16x32_bf16 v[20:23], v[128:131], v[164:167], v[20:23]
  ds_read_b64_tr_b16 v[210:211], v6 offset:53248
  v_mfma_f32_16x16x32_bf16 v[24:27], v[128:131], v[168:171], v[24:27]
  ds_read_b64_tr_b16 v[176:177], v3 offset:28672
  v_mfma_f32_16x16x32_bf16 v[28:31], v[128:131], v[172:175], v[28:31]
  ds_read_b64_tr_b16 v[178:179], v3 offset:32256
  v_mfma_f32_16x16x32_bf16 v[32:35], v[132:135], v[160:163], v[32:35]
  ds_read_b64_tr_b16 v[212:213], v7 offset:49152
  v_mfma_f32_16x16x32_bf16 v[36:39], v[132:135], v[164:167], v[36:39]
  ds_read_b64_tr_b16 v[214:215], v7 offset:53248
  v_mfma_f32_16x16x32_bf16 v[40:43], v[132:135], v[168:171], v[40:43]
  ds_read_b64_tr_b16 v[216:217], v8 offset:49152
  v_mfma_f32_16x16x32_bf16 v[44:47], v[132:135], v[172:175], v[44:47]
  ds_read_b64_tr_b16 v[218:219], v8 offset:53248
  v_mfma_f32_16x16x32_bf16 v[48:51], v[136:139], v[160:163], v[48:51]
  ds_read_b64_tr_b16 v[220:221], v9 offset:49152
  v_mfma_f32_16x16x32_bf16 v[52:55], v[136:139], v[164:167], v[52:55]
  ds_read_b64_tr_b16 v[222:223], v9 offset:53248
  v_mfma_f32_16x16x32_bf16 v[56:59], v[136:139], v[168:171], v[56:59]
  ds_read_b64_tr_b16 v[180:181], v3 offset:35840
  v_mfma_f32_16x16x32_bf16 v[60:63], v[136:139], v[172:175], v[60:63]
  ds_read_b64_tr_b16 v[182:183], v3 offset:39424
  v_mfma_f32_16x16x32_bf16 v[64:67], v[140:143], v[160:163], v[64:67]
  ds_read_b64_tr_b16 v[184:185], v3 offset:28704
  v_mfma_f32_16x16x32_bf16 v[68:71], v[140:143], v[164:167], v[68:71]
  ds_read_b64_tr_b16 v[186:187], v3 offset:32288
  v_mfma_f32_16x16x32_bf16 v[72:75], v[140:143], v[168:171], v[72:75]
  ds_read_b64_tr_b16 v[188:189], v3 offset:35872
  v_mfma_f32_16x16x32_bf16 v[76:79], v[140:143], v[172:175], v[76:79]
  ds_read_b64_tr_b16 v[190:191], v3 offset:39456
  v_mfma_f32_16x16x32_bf16 v[80:83], v[144:147], v[160:163], v[80:83]
  ds_read_b64_tr_b16 v[192:193], v3 offset:28736
  v_mfma_f32_16x16x32_bf16 v[84:87], v[144:147], v[164:167], v[84:87]
  ds_read_b64_tr_b16 v[194:195], v3 offset:32320
  v_mfma_f32_16x16x32_bf16 v[88:91], v[144:147], v[168:171], v[88:91]
  ds_read_b64_tr_b16 v[196:197], v3 offset:35904
  v_mfma_f32_16x16x32_bf16 v[92:95], v[144:147], v[172:175], v[92:95]
  ds_read_b64_tr_b16 v[198:199], v3 offset:39488
  v_mfma_f32_16x16x32_bf16 v[96:99], v[148:151], v[160:163], v[96:99]
  ds_read_b64_tr_b16 v[200:201], v5 offset:28672
  v_mfma_f32_16x16x32_bf16 v[100:103], v[148:151], v[164:167], v[100:103]
  ds_read_b64_tr_b16 v[202:203], v5 offset:32256
  v_mfma_f32_16x16x32_bf16 v[104:107], v[148:151], v[168:171], v[104:107]
  ds_read_b64_tr_b16 v[204:205], v5 offset:35840
  v_mfma_f32_16x16x32_bf16 v[108:111], v[148:151], v[172:175], v[108:111]
  ds_read_b64_tr_b16 v[206:207], v5 offset:39424
  v_mfma_f32_16x16x32_bf16 v[112:115], v[152:155], v[160:163], v[112:115]
  v_mfma_f32_16x16x32_bf16 v[116:119], v[152:155], v[164:167], v[116:119]
  v_mfma_f32_16x16x32_bf16 v[120:123], v[156:159], v[160:163], v[120:123]
  v_mfma_f32_16x16x32_bf16 v[124:127], v[156:159], v[164:167], v[124:127]
  s_waitcnt lgkmcnt(0)
  s_barrier
  v_mfma_f32_16x16x32_bf16 v[16:19], v[176:179], v[208:211], v[16:19]
  ds_read_b64_tr_b16 v[160:161], v6 offset:0
  v_mfma_f32_16x16x32_bf16 v[20:23], v[176:179], v[212:215], v[20:23]
  ds_read_b64_tr_b16 v[162:163], v6 offset:4096
  v_mfma_f32_16x16x32_bf16 v[24:27], v[176:179], v[216:219], v[24:27]
  ds_read_b64_tr_b16 v[128:129], v2 offset:0
  v_mfma_f32_16x16x32_bf16 v[28:31], v[176:179], v[220:223], v[28:31]
  ds_read_b64_tr_b16 v[130:131], v2 offset:3584
  v_mfma_f32_16x16x32_bf16 v[32:35], v[180:183], v[208:211], v[32:35]
  ds_read_b64_tr_b16 v[164:165], v7 offset:0
  v_mfma_f32_16x16x32_bf16 v[36:39], v[180:183], v[212:215], v[36:39]
  ds_read_b64_tr_b16 v[166:167], v7 offset:4096
  v_mfma_f32_16x16x32_bf16 v[40:43], v[180:183], v[216:219], v[40:43]
  ds_read_b64_tr_b16 v[168:169], v8 offset:0
  v_mfma_f32_16x16x32_bf16 v[44:47], v[180:183], v[220:223], v[44:47]
  ds_read_b64_tr_b16 v[170:171], v8 offset:4096
  v_mfma_f32_16x16x32_bf16 v[48:51], v[184:187], v[208:211], v[48:51]
  ds_read_b64_tr_b16 v[172:173], v9 offset:0
  v_mfma_f32_16x16x32_bf16 v[52:55], v[184:187], v[212:215], v[52:55]
  ds_read_b64_tr_b16 v[174:175], v9 offset:4096
  v_mfma_f32_16x16x32_bf16 v[56:59], v[184:187], v[216:219], v[56:59]
  ds_read_b64_tr_b16 v[132:133], v2 offset:7168
  v_mfma_f32_16x16x32_bf16 v[60:63], v[184:187], v[220:223], v[60:63]
  ds_read_b64_tr_b16 v[134:135], v2 offset:10752
  v_mfma_f32_16x16x32_bf16 v[64:67], v[188:191], v[208:211], v[64:67]
  ds_read_b64_tr_b16 v[136:137], v2 offset:32
  v_mfma_f32_16x16x32_bf16 v[68:71], v[188:191], v[212:215], v[68:71]
  ds_read_b64_tr_b16 v[138:139], v2 offset:3616
  v_mfma_f32_16x16x32_bf16 v[72:75], v[188:191], v[216:219], v[72:75]
  ds_read_b64_tr_b16 v[140:141], v2 offset:7200
  v_mfma_f32_16x16x32_bf16 v[76:79], v[188:191], v[220:223], v[76:79]
  ds_read_b64_tr_b16 v[142:143], v2 offset:10784
  v_mfma_f32_16x16x32_bf16 v[80:83], v[192:195], v[208:211], v[80:83]
  ds_read_b64_tr_b16 v[144:145], v2 offset:64
  v_mfma_f32_16x16x32_bf16 v[84:87], v[192:195], v[212:215], v[84:87]
  ds_read_b64_tr_b16 v[146:147], v2 offset:3648
  v_mfma_f32_16x16x32_bf16 v[88:91], v[192:195], v[216:219], v[88:91]
  ds_read_b64_tr_b16 v[148:149], v2 offset:7232
  v_mfma_f32_16x16x32_bf16 v[92:95], v[192:195], v[220:223], v[92:95]
  ds_read_b64_tr_b16 v[150:151], v2 offset:10816
  v_mfma_f32_16x16x32_bf16 v[96:99], v[196:199], v[208:211], v[96:99]
  ds_read_b64_tr_b16 v[152:153], v4 offset:0
  v_mfma_f32_16x16x32_bf16 v[100:103], v[196:199], v[212:215], v[100:103]
  ds_read_b64_tr_b16 v[154:155], v4 offset:3584
  v_mfma_f32_16x16x32_bf16 v[104:107], v[196:199], v[216:219], v[104:107]
  ds_read_b64_tr_b16 v[156:157], v4 offset:7168
  v_mfma_f32_16x16x32_bf16 v[108:111], v[196:199], v[220:223], v[108:111]
  ds_read_b64_tr_b16 v[158:159], v4 offset:10752
  v_mfma_f32_16x16x32_bf16 v[112:115], v[200:203], v[208:211], v[112:115]
  v_mfma_f32_16x16x32_bf16 v[116:119], v[200:203], v[212:215], v[116:119]
  v_mfma_f32_16x16x32_bf16 v[120:123], v[204:207], v[208:211], v[120:123]
  v_mfma_f32_16x16x32_bf16 v[124:127], v[204:207], v[212:215], v[124:127]
  s_waitcnt lgkmcnt(0)
  v_mfma_f32_16x16x32_bf16 v[16:19], v[128:131], v[160:163], v[16:19]
  ds_read_b64_tr_b16 v[208:209], v6 offset:8192
  v_mfma_f32_16x16x32_bf16 v[20:23], v[128:131], v[164:167], v[20:23]
  ds_read_b64_tr_b16 v[210:211], v6 offset:12288
  v_mfma_f32_16x16x32_bf16 v[24:27], v[128:131], v[168:171], v[24:27]
  ds_read_b64_tr_b16 v[176:177], v2 offset:14336
  v_mfma_f32_16x16x32_bf16 v[28:31], v[128:131], v[172:175], v[28:31]
  ds_read_b64_tr_b16 v[178:179], v2 offset:17920
  v_mfma_f32_16x16x32_bf16 v[32:35], v[132:135], v[160:163], v[32:35]
  ds_read_b64_tr_b16 v[212:213], v7 offset:8192
  v_mfma_f32_16x16x32_bf16 v[36:39], v[132:135], v[164:167], v[36:39]
  ds_read_b64_tr_b16 v[214:215], v7 offset:12288
  v_mfma_f32_16x16x32_bf16 v[40:43], v[132:135], v[168:171], v[40:43]
  ds_read_b64_tr_b16 v[216:217], v8 offset:8192
  v_mfma_f32_16x16x32_bf16 v[44:47], v[132:135], v[172:175], v[44:47]
  ds_read_b64_tr_b16 v[218:219], v8 offset:12288
  v_mfma_f32_16x16x32_bf16 v[48:51], v[136:139], v[160:163], v[48:51]
  ds_read_b64_tr_b16 v[220:221], v9 offset:8192
  v_mfma_f32_16x16x32_bf16 v[52:55], v[136:139], v[164:167], v[52:55]
  ds_read_b64_tr_b16 v[222:223], v9 offset:12288
  v_mfma_f32_16x16x32_bf16 v[56:59], v[136:139], v[168:171], v[56:59]
  ds_read_b64_tr_b16 v[180:181], v2 offset:21504
  v_mfma_f32_16x16x32_bf16 v[60:63], v[136:139], v[172:175], v[60:63]
  ds_read_b64_tr_b16 v[182:183], v2 offset:25088
  v_mfma_f32_16x16x32_bf16 v[64:67], v[140:143], v[160:163], v[64:67]
  ds_read_b64_tr_b16 v[184:185], v2 offset:14368
  v_mfma_f32_16x16x32_bf16 v[68:71], v[140:143], v[164:167], v[68:71]
  ds_read_b64_tr_b16 v[186:187], v2 offset:17952
  v_mfma_f32_16x16x32_bf16 v[72:75], v[140:143], v[168:171], v[72:75]
  ds_read_b64_tr_b16 v[188:189], v2 offset:21536
  v_mfma_f32_16x16x32_bf16 v[76:79], v[140:143], v[172:175], v[76:79]
  ds_read_b64_tr_b16 v[190:191], v2 offset:25120
  v_mfma_f32_16x16x32_bf16 v[80:83], v[144:147], v[160:163], v[80:83]
  ds_read_b64_tr_b16 v[192:193], v2 offset:14400
  v_mfma_f32_16x16x32_bf16 v[84:87], v[144:147], v[164:167], v[84:87]
  ds_read_b64_tr_b16 v[194:195], v2 offset:17984
  v_mfma_f32_16x16x32_bf16 v[88:91], v[144:147], v[168:171], v[88:91]
  ds_read_b64_tr_b16 v[196:197], v2 offset:21568
  v_mfma_f32_16x16x32_bf16 v[92:95], v[144:147], v[172:175], v[92:95]
  ds_read_b64_tr_b16 v[198:199], v2 offset:25152
  v_mfma_f32_16x16x32_bf16 v[96:99], v[148:151], v[160:163], v[96:99]
  ds_read_b64_tr_b16 v[200:201], v4 offset:14336
  v_mfma_f32_16x16x32_bf16 v[100:103], v[148:151], v[164:167], v[100:103]
  ds_read_b64_tr_b16 v[202:203], v4 offset:17920
  v_mfma_f32_16x16x32_bf16 v[104:107], v[148:151], v[168:171], v[104:107]
  ds_read_b64_tr_b16 v[204:205], v4 offset:21504
  v_mfma_f32_16x16x32_bf16 v[108:111], v[148:151], v[172:175], v[108:111]
  ds_read_b64_tr_b16 v[206:207], v4 offset:25088
  v_mfma_f32_16x16x32_bf16 v[112:115], v[152:155], v[160:163], v[112:115]
  v_mfma_f32_16x16x32_bf16 v[116:119], v[152:155], v[164:167], v[116:119]
  v_mfma_f32_16x16x32_bf16 v[120:123], v[156:159], v[160:163], v[120:123]
  v_mfma_f32_16x16x32_bf16 v[124:127], v[156:159], v[164:167], v[124:127]
  s_waitcnt lgkmcnt(0)
  s_barrier
  s_waitcnt vmcnt(0)
  v_mfma_f32_16x16x32_bf16 v[16:19], v[176:179], v[208:211], v[16:19]
  v_mfma_f32_16x16x32_bf16 v[20:23], v[176:179], v[212:215], v[20:23]
  v_add_u32 v14, s82, v13
  ds_read_b128 v[128:131], v13
  v_mfma_f32_16x16x32_bf16 v[24:27], v[176:179], v[216:219], v[24:27]
  v_mfma_f32_16x16x32_bf16 v[28:31], v[176:179], v[220:223], v[28:31]
  ds_read_b128 v[132:135], v13 offset:256
  v_mfma_f32_16x16x32_bf16 v[32:35], v[180:183], v[208:211], v[32:35]
  v_mfma_f32_16x16x32_bf16 v[36:39], v[180:183], v[212:215], v[36:39]
  ds_read_b128 v[136:139], v14
  v_mfma_f32_16x16x32_bf16 v[40:43], v[180:183], v[216:219], v[40:43]
  v_mfma_f32_16x16x32_bf16 v[44:47], v[180:183], v[220:223], v[44:47]
  ds_read_b128 v[140:143], v14 offset:256
  v_mfma_f32_16x16x32_bf16 v[48:51], v[184:187], v[208:211], v[48:51]
  v_mfma_f32_16x16x32_bf16 v[52:55], v[184:187], v[212:215], v[52:55]
  ds_read_b128 v[224:227], v11 offset:0
  v_mfma_f32_16x16x32_bf16 v[56:59], v[184:187], v[216:219], v[56:59]
  v_mfma_f32_16x16x32_bf16 v[60:63], v[184:187], v[220:223], v[60:63]
  ds_read_b128 v[228:231], v11 offset:448
  v_mfma_f32_16x16x32_bf16 v[64:67], v[188:191], v[208:211], v[64:67]
  v_mfma_f32_16x16x32_bf16 v[68:71], v[188:191], v[212:215], v[68:71]
  ds_read_b128 v[232:235], v11 offset:64
  v_mfma_f32_16x16x32_bf16 v[72:75], v[188:191], v[216:219], v[72:75]
  v_mfma_f32_16x16x32_bf16 v[76:79], v[188:191], v[220:223], v[76:79]
  ds_read_b128 v[236:239], v11 offset:512
  v_mfma_f32_16x16x32_bf16 v[80:83], v[192:195], v[208:211], v[80:83]
  v_mfma_f32_16x16x32_bf16 v[84:87], v[192:195], v[212:215], v[84:87]
  ds_read_b128 v[240:243], v11 offset:128
  v_mfma_f32_16x16x32_bf16 v[88:91], v[192:195], v[216:219], v[88:91]
  v_mfma_f32_16x16x32_bf16 v[92:95], v[192:195], v[220:223], v[92:95]
  ds_read_b128 v[244:247], v11 offset:576
  v_mfma_f32_16x16x32_bf16 v[96:99], v[196:199], v[208:211], v[96:99]
  v_mfma_f32_16x16x32_bf16 v[100:103], v[196:199], v[212:215], v[100:103]
  ds_read_b128 v[248:251], v12 offset:192
  v_mfma_f32_16x16x32_bf16 v[104:107], v[196:199], v[216:219], v[104:107]
  v_mfma_f32_16x16x32_bf16 v[108:111], v[196:199], v[220:223], v[108:111]
  ds_read_b128 v[252:255], v12 offset:640
  v_mfma_f32_16x16x32_bf16 v[112:115], v[200:203], v[208:211], v[112:115]
  v_mfma_f32_16x16x32_bf16 v[116:119], v[200:203], v[212:215], v[116:119]
  v_mfma_f32_16x16x32_bf16 v[120:123], v[204:207], v[208:211], v[120:123]
  v_mfma_f32_16x16x32_bf16 v[124:127], v[204:207], v[212:215], v[124:127]
  s_waitcnt lgkmcnt(0)
  v_pk_fma_f32 v[16:17], v[224:225], v[128:129], v[16:17] op_sel:[0,0,0] op_sel_hi:[1,0,1]
  v_pk_fma_f32 v[32:33], v[228:229], v[128:129], v[32:33] op_sel:[0,0,0] op_sel_hi:[1,0,1]
  v_pk_fma_f32 v[18:19], v[226:227], v[128:129], v[18:19] op_sel:[0,0,0] op_sel_hi:[1,0,1]
  v_pk_fma_f32 v[34:35], v[230:231], v[128:129], v[34:35] op_sel:[0,0,0] op_sel_hi:[1,0,1]
  v_pk_fma_f32 v[20:21], v[224:225], v[132:133], v[20:21] op_sel:[0,0,0] op_sel_hi:[1,0,1]
  v_pk_fma_f32 v[36:37], v[228:229], v[132:133], v[36:37] op_sel:[0,0,0] op_sel_hi:[1,0,1]
  v_pk_fma_f32 v[22:23], v[226:227], v[132:133], v[22:23] op_sel:[0,0,0] op_sel_hi:[1,0,1]
  v_pk_fma_f32 v[38:39], v[230:231], v[132:133], v[38:39] op_sel:[0,0,0] op_sel_hi:[1,0,1]
  v_pk_mul_f32 v[144:145], v[16:17], v[128:129] op_sel:[0,1] op_sel_hi:[1,1]
  v_pk_mul_f32 v[146:147], v[18:19], v[128:129] op_sel:[0,1] op_sel_hi:[1,1]
  v_pk_mul_f32 v[148:149], v[20:21], v[132:133] op_sel:[0,1] op_sel_hi:[1,1]
  v_pk_mul_f32 v[150:151], v[22:23], v[132:133] op_sel:[0,1] op_sel_hi:[1,1]
  v_exp_f32 v144, v144
  v_exp_f32 v145, v145
  v_exp_f32 v146, v146
  v_exp_f32 v147, v147
  v_exp_f32 v148, v148
  v_exp_f32 v149, v149
  v_exp_f32 v150, v150
  v_exp_f32 v151, v151
  v_pk_mul_f32 v[16:17], v[16:17], v[32:33]
  v_pk_mul_f32 v[18:19], v[18:19], v[34:35]
  v_pk_mul_f32 v[20:21], v[20:21], v[36:37]
  v_pk_mul_f32 v[22:23], v[22:23], v[38:39]
  v_pk_fma_f32 v[144:145], v[144:145], v[130:131], v[130:131] op_sel:[0,0,0] op_sel_hi:[1,0,0]
  v_pk_fma_f32 v[146:147], v[146:147], v[130:131], v[130:131] op_sel:[0,0,0] op_sel_hi:[1,0,0]
  v_pk_fma_f32 v[148:149], v[148:149], v[134:135], v[134:135] op_sel:[0,0,0] op_sel_hi:[1,0,0]
  v_pk_fma_f32 v[150:151], v[150:151], v[134:135], v[134:135] op_sel:[0,0,0] op_sel_hi:[1,0,0]
  v_rcp_f32 v144, v144
  v_rcp_f32 v145, v145
  v_rcp_f32 v146, v146
  v_rcp_f32 v147, v147
  v_rcp_f32 v148, v148
  v_rcp_f32 v149, v149
  v_rcp_f32 v150, v150
  v_rcp_f32 v151, v151
  s_nop 0
  v_pk_mul_f32 v[16:17], v[16:17], v[144:145]
  v_pk_mul_f32 v[18:19], v[18:19], v[146:147]
  v_pk_mul_f32 v[20:21], v[20:21], v[148:149]
  v_pk_mul_f32 v[22:23], v[22:23], v[150:151]
  v_cvt_pk_bf16_f32 v152, v16, v17
  v_cvt_pk_bf16_f32 v153, v18, v19
  v_cvt_pk_bf16_f32 v154, v20, v21
  v_cvt_pk_bf16_f32 v155, v22, v23
  s_nop 1
  v_permlane16_swap_b32 v152, v154
  v_permlane16_swap_b32 v153, v155
  buffer_store_dwordx4 v[152:155], v10, s[44:47], s83 offen offset:0 sc1
  v_pk_fma_f32 v[48:49], v[232:233], v[128:129], v[48:49] op_sel:[0,0,0] op_sel_hi:[1,0,1]
  v_pk_fma_f32 v[64:65], v[236:237], v[128:129], v[64:65] op_sel:[0,0,0] op_sel_hi:[1,0,1]
  v_pk_fma_f32 v[50:51], v[234:235], v[128:129], v[50:51] op_sel:[0,0,0] op_sel_hi:[1,0,1]
  v_pk_fma_f32 v[66:67], v[238:239], v[128:129], v[66:67] op_sel:[0,0,0] op_sel_hi:[1,0,1]
  v_pk_fma_f32 v[52:53], v[232:233], v[132:133], v[52:53] op_sel:[0,0,0] op_sel_hi:[1,0,1]
  v_pk_fma_f32 v[68:69], v[236:237], v[132:133], v[68:69] op_sel:[0,0,0] op_sel_hi:[1,0,1]
  v_pk_fma_f32 v[54:55], v[234:235], v[132:133], v[54:55] op_sel:[0,0,0] op_sel_hi:[1,0,1]
  v_pk_fma_f32 v[70:71], v[238:239], v[132:133], v[70:71] op_sel:[0,0,0] op_sel_hi:[1,0,1]
  v_pk_mul_f32 v[160:161], v[48:49], v[128:129] op_sel:[0,1] op_sel_hi:[1,1]
  v_pk_mul_f32 v[162:163], v[50:51], v[128:129] op_sel:[0,1] op_sel_hi:[1,1]
  v_pk_mul_f32 v[164:165], v[52:53], v[132:133] op_sel:[0,1] op_sel_hi:[1,1]
  v_pk_mul_f32 v[166:167], v[54:55], v[132:133] op_sel:[0,1] op_sel_hi:[1,1]
  v_exp_f32 v160, v160
  v_exp_f32 v161, v161
  v_exp_f32 v162, v162
  v_exp_f32 v163, v163
  v_exp_f32 v164, v164
  v_exp_f32 v165, v165
  v_exp_f32 v166, v166
  v_exp_f32 v167, v167
  v_pk_mul_f32 v[48:49], v[48:49], v[64:65]
  v_pk_mul_f32 v[50:51], v[50:51], v[66:67]
  v_pk_mul_f32 v[52:53], v[52:53], v[68:69]
  v_pk_mul_f32 v[54:55], v[54:55], v[70:71]
  v_pk_fma_f32 v[160:161], v[160:161], v[130:131], v[130:131] op_sel:[0,0,0] op_sel_hi:[1,0,0]
  v_pk_fma_f32 v[162:163], v[162:163], v[130:131], v[130:131] op_sel:[0,0,0] op_sel_hi:[1,0,0]
  v_pk_fma_f32 v[164:165], v[164:165], v[134:135], v[134:135] op_sel:[0,0,0] op_sel_hi:[1,0,0]
  v_pk_fma_f32 v[166:167], v[166:167], v[134:135], v[134:135] op_sel:[0,0,0] op_sel_hi:[1,0,0]
  v_rcp_f32 v160, v160
  v_rcp_f32 v161, v161
  v_rcp_f32 v162, v162
  v_rcp_f32 v163, v163
  v_rcp_f32 v164, v164
  v_rcp_f32 v165, v165
  v_rcp_f32 v166, v166
  v_rcp_f32 v167, v167
  s_nop 0
  v_pk_mul_f32 v[48:49], v[48:49], v[160:161]
  v_pk_mul_f32 v[50:51], v[50:51], v[162:163]
  v_pk_mul_f32 v[52:53], v[52:53], v[164:165]
  v_pk_mul_f32 v[54:55], v[54:55], v[166:167]
  v_cvt_pk_bf16_f32 v168, v48, v49
  v_cvt_pk_bf16_f32 v169, v50, v51
  v_cvt_pk_bf16_f32 v170, v52, v53
  v_cvt_pk_bf16_f32 v171, v54, v55
  s_nop 1
  v_permlane16_swap_b32 v168, v170
  v_permlane16_swap_b32 v169, v171
  buffer_store_dwordx4 v[168:171], v10, s[44:47], s83 offen offset:1024 sc1
  v_pk_fma_f32 v[80:81], v[240:241], v[128:129], v[80:81] op_sel:[0,0,0] op_sel_hi:[1,0,1]
  v_pk_fma_f32 v[96:97], v[244:245], v[128:129], v[96:97] op_sel:[0,0,0] op_sel_hi:[1,0,1]
  v_pk_fma_f32 v[82:83], v[242:243], v[128:129], v[82:83] op_sel:[0,0,0] op_sel_hi:[1,0,1]
  v_pk_fma_f32 v[98:99], v[246:247], v[128:129], v[98:99] op_sel:[0,0,0] op_sel_hi:[1,0,1]
  v_pk_fma_f32 v[84:85], v[240:241], v[132:133], v[84:85] op_sel:[0,0,0] op_sel_hi:[1,0,1]
  v_pk_fma_f32 v[100:101], v[244:245], v[132:133], v[100:101] op_sel:[0,0,0] op_sel_hi:[1,0,1]
  v_pk_fma_f32 v[86:87], v[242:243], v[132:133], v[86:87] op_sel:[0,0,0] op_sel_hi:[1,0,1]
  v_pk_fma_f32 v[102:103], v[246:247], v[132:133], v[102:103] op_sel:[0,0,0] op_sel_hi:[1,0,1]
  v_pk_mul_f32 v[144:145], v[80:81], v[128:129] op_sel:[0,1] op_sel_hi:[1,1]
  v_pk_mul_f32 v[146:147], v[82:83], v[128:129] op_sel:[0,1] op_sel_hi:[1,1]
  v_pk_mul_f32 v[148:149], v[84:85], v[132:133] op_sel:[0,1] op_sel_hi:[1,1]
  v_pk_mul_f32 v[150:151], v[86:87], v[132:133] op_sel:[0,1] op_sel_hi:[1,1]
  v_exp_f32 v144, v144
  v_exp_f32 v145, v145
  v_exp_f32 v146, v146
  v_exp_f32 v147, v147
  v_exp_f32 v148, v148
  v_exp_f32 v149, v149
  v_exp_f32 v150, v150
  v_exp_f32 v151, v151
  v_pk_mul_f32 v[80:81], v[80:81], v[96:97]
  v_pk_mul_f32 v[82:83], v[82:83], v[98:99]
  v_pk_mul_f32 v[84:85], v[84:85], v[100:101]
  v_pk_mul_f32 v[86:87], v[86:87], v[102:103]
  v_pk_fma_f32 v[144:145], v[144:145], v[130:131], v[130:131] op_sel:[0,0,0] op_sel_hi:[1,0,0]
  v_pk_fma_f32 v[146:147], v[146:147], v[130:131], v[130:131] op_sel:[0,0,0] op_sel_hi:[1,0,0]
  v_pk_fma_f32 v[148:149], v[148:149], v[134:135], v[134:135] op_sel:[0,0,0] op_sel_hi:[1,0,0]
  v_pk_fma_f32 v[150:151], v[150:151], v[134:135], v[134:135] op_sel:[0,0,0] op_sel_hi:[1,0,0]
  v_rcp_f32 v144, v144
  v_rcp_f32 v145, v145
  v_rcp_f32 v146, v146
  v_rcp_f32 v147, v147
  v_rcp_f32 v148, v148
  v_rcp_f32 v149, v149
  v_rcp_f32 v150, v150
  v_rcp_f32 v151, v151
  s_nop 0
  v_pk_mul_f32 v[80:81], v[80:81], v[144:145]
  v_pk_mul_f32 v[82:83], v[82:83], v[146:147]
  v_pk_mul_f32 v[84:85], v[84:85], v[148:149]
  v_pk_mul_f32 v[86:87], v[86:87], v[150:151]
  v_cvt_pk_bf16_f32 v152, v80, v81
  v_cvt_pk_bf16_f32 v153, v82, v83
  v_cvt_pk_bf16_f32 v154, v84, v85
  v_cvt_pk_bf16_f32 v155, v86, v87
  s_nop 1
  v_permlane16_swap_b32 v152, v154
  v_permlane16_swap_b32 v153, v155
  buffer_store_dwordx4 v[152:155], v10, s[44:47], s83 offen offset:2048 sc1
  v_pk_fma_f32 v[112:113], v[248:249], v[128:129], v[112:113] op_sel:[0,0,0] op_sel_hi:[1,0,1]
  v_pk_fma_f32 v[120:121], v[252:253], v[128:129], v[120:121] op_sel:[0,0,0] op_sel_hi:[1,0,1]
  v_pk_fma_f32 v[114:115], v[250:251], v[128:129], v[114:115] op_sel:[0,0,0] op_sel_hi:[1,0,1]
  v_pk_fma_f32 v[122:123], v[254:255], v[128:129], v[122:123] op_sel:[0,0,0] op_sel_hi:[1,0,1]
  v_pk_fma_f32 v[116:117], v[248:249], v[132:133], v[116:117] op_sel:[0,0,0] op_sel_hi:[1,0,1]
  v_pk_fma_f32 v[124:125], v[252:253], v[132:133], v[124:125] op_sel:[0,0,0] op_sel_hi:[1,0,1]
  v_pk_fma_f32 v[118:119], v[250:251], v[132:133], v[118:119] op_sel:[0,0,0] op_sel_hi:[1,0,1]
  v_pk_fma_f32 v[126:127], v[254:255], v[132:133], v[126:127] op_sel:[0,0,0] op_sel_hi:[1,0,1]
  v_pk_mul_f32 v[160:161], v[112:113], v[128:129] op_sel:[0,1] op_sel_hi:[1,1]
  v_pk_mul_f32 v[162:163], v[114:115], v[128:129] op_sel:[0,1] op_sel_hi:[1,1]
  v_pk_mul_f32 v[164:165], v[116:117], v[132:133] op_sel:[0,1] op_sel_hi:[1,1]
  v_pk_mul_f32 v[166:167], v[118:119], v[132:133] op_sel:[0,1] op_sel_hi:[1,1]
  v_exp_f32 v160, v160
  v_exp_f32 v161, v161
  v_exp_f32 v162, v162
  v_exp_f32 v163, v163
  v_exp_f32 v164, v164
  v_exp_f32 v165, v165
  v_exp_f32 v166, v166
  v_exp_f32 v167, v167
  v_pk_mul_f32 v[112:113], v[112:113], v[120:121]
  v_pk_mul_f32 v[114:115], v[114:115], v[122:123]
  v_pk_mul_f32 v[116:117], v[116:117], v[124:125]
  v_pk_mul_f32 v[118:119], v[118:119], v[126:127]
  v_pk_fma_f32 v[160:161], v[160:161], v[130:131], v[130:131] op_sel:[0,0,0] op_sel_hi:[1,0,0]
  v_pk_fma_f32 v[162:163], v[162:163], v[130:131], v[130:131] op_sel:[0,0,0] op_sel_hi:[1,0,0]
  v_pk_fma_f32 v[164:165], v[164:165], v[134:135], v[134:135] op_sel:[0,0,0] op_sel_hi:[1,0,0]
  v_pk_fma_f32 v[166:167], v[166:167], v[134:135], v[134:135] op_sel:[0,0,0] op_sel_hi:[1,0,0]
  v_rcp_f32 v160, v160
  v_rcp_f32 v161, v161
  v_rcp_f32 v162, v162
  v_rcp_f32 v163, v163
  v_rcp_f32 v164, v164
  v_rcp_f32 v165, v165
  v_rcp_f32 v166, v166
  v_rcp_f32 v167, v167
  s_nop 0
  v_pk_mul_f32 v[112:113], v[112:113], v[160:161]
  v_pk_mul_f32 v[114:115], v[114:115], v[162:163]
  v_pk_mul_f32 v[116:117], v[116:117], v[164:165]
  v_pk_mul_f32 v[118:119], v[118:119], v[166:167]
  v_cvt_pk_bf16_f32 v168, v112, v113
  v_cvt_pk_bf16_f32 v169, v114, v115
  v_cvt_pk_bf16_f32 v170, v116, v117
  v_cvt_pk_bf16_f32 v171, v118, v119
  s_nop 1
  v_permlane16_swap_b32 v168, v170
  v_permlane16_swap_b32 v169, v171
  buffer_store_dwordx4 v[168:171], v10, s[44:47], s85 offen offset:0 sc1
  v_pk_fma_f32 v[24:25], v[224:225], v[136:137], v[24:25] op_sel:[0,0,0] op_sel_hi:[1,0,1]
  v_pk_fma_f32 v[40:41], v[228:229], v[136:137], v[40:41] op_sel:[0,0,0] op_sel_hi:[1,0,1]
  v_pk_fma_f32 v[26:27], v[226:227], v[136:137], v[26:27] op_sel:[0,0,0] op_sel_hi:[1,0,1]
  v_pk_fma_f32 v[42:43], v[230:231], v[136:137], v[42:43] op_sel:[0,0,0] op_sel_hi:[1,0,1]
  v_pk_fma_f32 v[28:29], v[224:225], v[140:141], v[28:29] op_sel:[0,0,0] op_sel_hi:[1,0,1]
  v_pk_fma_f32 v[44:45], v[228:229], v[140:141], v[44:45] op_sel:[0,0,0] op_sel_hi:[1,0,1]
  v_pk_fma_f32 v[30:31], v[226:227], v[140:141], v[30:31] op_sel:[0,0,0] op_sel_hi:[1,0,1]
  v_pk_fma_f32 v[46:47], v[230:231], v[140:141], v[46:47] op_sel:[0,0,0] op_sel_hi:[1,0,1]
  v_pk_mul_f32 v[144:145], v[24:25], v[136:137] op_sel:[0,1] op_sel_hi:[1,1]
  v_pk_mul_f32 v[146:147], v[26:27], v[136:137] op_sel:[0,1] op_sel_hi:[1,1]
  v_pk_mul_f32 v[148:149], v[28:29], v[140:141] op_sel:[0,1] op_sel_hi:[1,1]
  v_pk_mul_f32 v[150:151], v[30:31], v[140:141] op_sel:[0,1] op_sel_hi:[1,1]
  v_exp_f32 v144, v144
  v_exp_f32 v145, v145
  v_exp_f32 v146, v146
  v_exp_f32 v147, v147
  v_exp_f32 v148, v148
  v_exp_f32 v149, v149
  v_exp_f32 v150, v150
  v_exp_f32 v151, v151
  v_pk_mul_f32 v[24:25], v[24:25], v[40:41]
  v_pk_mul_f32 v[26:27], v[26:27], v[42:43]
  v_pk_mul_f32 v[28:29], v[28:29], v[44:45]
  v_pk_mul_f32 v[30:31], v[30:31], v[46:47]
  v_pk_fma_f32 v[144:145], v[144:145], v[138:139], v[138:139] op_sel:[0,0,0] op_sel_hi:[1,0,0]
  v_pk_fma_f32 v[146:147], v[146:147], v[138:139], v[138:139] op_sel:[0,0,0] op_sel_hi:[1,0,0]
  v_pk_fma_f32 v[148:149], v[148:149], v[142:143], v[142:143] op_sel:[0,0,0] op_sel_hi:[1,0,0]
  v_pk_fma_f32 v[150:151], v[150:151], v[142:143], v[142:143] op_sel:[0,0,0] op_sel_hi:[1,0,0]
  v_rcp_f32 v144, v144
  v_rcp_f32 v145, v145
  v_rcp_f32 v146, v146
  v_rcp_f32 v147, v147
  v_rcp_f32 v148, v148
  v_rcp_f32 v149, v149
  v_rcp_f32 v150, v150
  v_rcp_f32 v151, v151
  s_nop 0
  v_pk_mul_f32 v[24:25], v[24:25], v[144:145]
  v_pk_mul_f32 v[26:27], v[26:27], v[146:147]
  v_pk_mul_f32 v[28:29], v[28:29], v[148:149]
  v_pk_mul_f32 v[30:31], v[30:31], v[150:151]
  v_cvt_pk_bf16_f32 v152, v24, v25
  v_cvt_pk_bf16_f32 v153, v26, v27
  v_cvt_pk_bf16_f32 v154, v28, v29
  v_cvt_pk_bf16_f32 v155, v30, v31
  s_nop 1
  v_permlane16_swap_b32 v152, v154
  v_permlane16_swap_b32 v153, v155
  buffer_store_dwordx4 v[152:155], v10, s[44:47], s84 offen offset:0 sc1
  v_pk_fma_f32 v[56:57], v[232:233], v[136:137], v[56:57] op_sel:[0,0,0] op_sel_hi:[1,0,1]
  v_pk_fma_f32 v[72:73], v[236:237], v[136:137], v[72:73] op_sel:[0,0,0] op_sel_hi:[1,0,1]
  v_pk_fma_f32 v[58:59], v[234:235], v[136:137], v[58:59] op_sel:[0,0,0] op_sel_hi:[1,0,1]
  v_pk_fma_f32 v[74:75], v[238:239], v[136:137], v[74:75] op_sel:[0,0,0] op_sel_hi:[1,0,1]
  v_pk_fma_f32 v[60:61], v[232:233], v[140:141], v[60:61] op_sel:[0,0,0] op_sel_hi:[1,0,1]
  v_pk_fma_f32 v[76:77], v[236:237], v[140:141], v[76:77] op_sel:[0,0,0] op_sel_hi:[1,0,1]
  v_pk_fma_f32 v[62:63], v[234:235], v[140:141], v[62:63] op_sel:[0,0,0] op_sel_hi:[1,0,1]
  v_pk_fma_f32 v[78:79], v[238:239], v[140:141], v[78:79] op_sel:[0,0,0] op_sel_hi:[1,0,1]
  v_pk_mul_f32 v[160:161], v[56:57], v[136:137] op_sel:[0,1] op_sel_hi:[1,1]
  v_pk_mul_f32 v[162:163], v[58:59], v[136:137] op_sel:[0,1] op_sel_hi:[1,1]
  v_pk_mul_f32 v[164:165], v[60:61], v[140:141] op_sel:[0,1] op_sel_hi:[1,1]
  v_pk_mul_f32 v[166:167], v[62:63], v[140:141] op_sel:[0,1] op_sel_hi:[1,1]
  v_exp_f32 v160, v160
  v_exp_f32 v161, v161
  v_exp_f32 v162, v162
  v_exp_f32 v163, v163
  v_exp_f32 v164, v164
  v_exp_f32 v165, v165
  v_exp_f32 v166, v166
  v_exp_f32 v167, v167
  v_pk_mul_f32 v[56:57], v[56:57], v[72:73]
  v_pk_mul_f32 v[58:59], v[58:59], v[74:75]
  v_pk_mul_f32 v[60:61], v[60:61], v[76:77]
  v_pk_mul_f32 v[62:63], v[62:63], v[78:79]
  v_pk_fma_f32 v[160:161], v[160:161], v[138:139], v[138:139] op_sel:[0,0,0] op_sel_hi:[1,0,0]
  v_pk_fma_f32 v[162:163], v[162:163], v[138:139], v[138:139] op_sel:[0,0,0] op_sel_hi:[1,0,0]
  v_pk_fma_f32 v[164:165], v[164:165], v[142:143], v[142:143] op_sel:[0,0,0] op_sel_hi:[1,0,0]
  v_pk_fma_f32 v[166:167], v[166:167], v[142:143], v[142:143] op_sel:[0,0,0] op_sel_hi:[1,0,0]
  v_rcp_f32 v160, v160
  v_rcp_f32 v161, v161
  v_rcp_f32 v162, v162
  v_rcp_f32 v163, v163
  v_rcp_f32 v164, v164
  v_rcp_f32 v165, v165
  v_rcp_f32 v166, v166
  v_rcp_f32 v167, v167
  s_nop 0
  v_pk_mul_f32 v[56:57], v[56:57], v[160:161]
  v_pk_mul_f32 v[58:59], v[58:59], v[162:163]
  v_pk_mul_f32 v[60:61], v[60:61], v[164:165]
  v_pk_mul_f32 v[62:63], v[62:63], v[166:167]
  v_cvt_pk_bf16_f32 v168, v56, v57
  v_cvt_pk_bf16_f32 v169, v58, v59
  v_cvt_pk_bf16_f32 v170, v60, v61
  v_cvt_pk_bf16_f32 v171, v62, v63
  s_nop 1
  v_permlane16_swap_b32 v168, v170
  v_permlane16_swap_b32 v169, v171
  buffer_store_dwordx4 v[168:171], v10, s[44:47], s84 offen offset:1024 sc1
  v_pk_fma_f32 v[88:89], v[240:241], v[136:137], v[88:89] op_sel:[0,0,0] op_sel_hi:[1,0,1]
  v_pk_fma_f32 v[104:105], v[244:245], v[136:137], v[104:105] op_sel:[0,0,0] op_sel_hi:[1,0,1]
  v_pk_fma_f32 v[90:91], v[242:243], v[136:137], v[90:91] op_sel:[0,0,0] op_sel_hi:[1,0,1]
  v_pk_fma_f32 v[106:107], v[246:247], v[136:137], v[106:107] op_sel:[0,0,0] op_sel_hi:[1,0,1]
  v_pk_fma_f32 v[92:93], v[240:241], v[140:141], v[92:93] op_sel:[0,0,0] op_sel_hi:[1,0,1]
  v_pk_fma_f32 v[108:109], v[244:245], v[140:141], v[108:109] op_sel:[0,0,0] op_sel_hi:[1,0,1]
  v_pk_fma_f32 v[94:95], v[242:243], v[140:141], v[94:95] op_sel:[0,0,0] op_sel_hi:[1,0,1]
  v_pk_fma_f32 v[110:111], v[246:247], v[140:141], v[110:111] op_sel:[0,0,0] op_sel_hi:[1,0,1]
  v_pk_mul_f32 v[144:145], v[88:89], v[136:137] op_sel:[0,1] op_sel_hi:[1,1]
  v_pk_mul_f32 v[146:147], v[90:91], v[136:137] op_sel:[0,1] op_sel_hi:[1,1]
  v_pk_mul_f32 v[148:149], v[92:93], v[140:141] op_sel:[0,1] op_sel_hi:[1,1]
  v_pk_mul_f32 v[150:151], v[94:95], v[140:141] op_sel:[0,1] op_sel_hi:[1,1]
  v_exp_f32 v144, v144
  v_exp_f32 v145, v145
  v_exp_f32 v146, v146
  v_exp_f32 v147, v147
  v_exp_f32 v148, v148
  v_exp_f32 v149, v149
  v_exp_f32 v150, v150
  v_exp_f32 v151, v151
  v_pk_mul_f32 v[88:89], v[88:89], v[104:105]
  v_pk_mul_f32 v[90:91], v[90:91], v[106:107]
  v_pk_mul_f32 v[92:93], v[92:93], v[108:109]
  v_pk_mul_f32 v[94:95], v[94:95], v[110:111]
  v_pk_fma_f32 v[144:145], v[144:145], v[138:139], v[138:139] op_sel:[0,0,0] op_sel_hi:[1,0,0]
  v_pk_fma_f32 v[146:147], v[146:147], v[138:139], v[138:139] op_sel:[0,0,0] op_sel_hi:[1,0,0]
  v_pk_fma_f32 v[148:149], v[148:149], v[142:143], v[142:143] op_sel:[0,0,0] op_sel_hi:[1,0,0]
  v_pk_fma_f32 v[150:151], v[150:151], v[142:143], v[142:143] op_sel:[0,0,0] op_sel_hi:[1,0,0]
  v_rcp_f32 v144, v144
  v_rcp_f32 v145, v145
  v_rcp_f32 v146, v146
  v_rcp_f32 v147, v147
  v_rcp_f32 v148, v148
  v_rcp_f32 v149, v149
  v_rcp_f32 v150, v150
  v_rcp_f32 v151, v151
  s_nop 0
  v_pk_mul_f32 v[88:89], v[88:89], v[144:145]
  v_pk_mul_f32 v[90:91], v[90:91], v[146:147]
  v_pk_mul_f32 v[92:93], v[92:93], v[148:149]
  v_pk_mul_f32 v[94:95], v[94:95], v[150:151]
  v_cvt_pk_bf16_f32 v152, v88, v89
  v_cvt_pk_bf16_f32 v153, v90, v91
  v_cvt_pk_bf16_f32 v154, v92, v93
  v_cvt_pk_bf16_f32 v155, v94, v95
  s_nop 1
  v_permlane16_swap_b32 v152, v154
  v_permlane16_swap_b32 v153, v155
  buffer_store_dwordx4 v[152:155], v10, s[44:47], s84 offen offset:2048 sc1
  v_mov_b32 v7, v1
  v_mov_b32 v4, v15
  v_xor_b32 v5, 32, v15
  s_barrier
  ds_read_b64_tr_b16 v[80:81], v4 offset:0
  ds_read_b64_tr_b16 v[82:83], v4 offset:512
  ds_read_b64_tr_b16 v[84:85], v5 offset:0
  ds_read_b64_tr_b16 v[86:87], v5 offset:512
  ds_read_b64_tr_b16 v[88:89], v4 offset:8192
  ds_read_b64_tr_b16 v[90:91], v4 offset:8704
  ds_read_b64_tr_b16 v[92:93], v5 offset:8192
  ds_read_b64_tr_b16 v[94:95], v5 offset:8704
  ds_read_b64_tr_b16 v[96:97], v4 offset:16384
  ds_read_b64_tr_b16 v[98:99], v4 offset:16896
  ds_read_b64_tr_b16 v[100:101], v5 offset:16384
  ds_read_b64_tr_b16 v[102:103], v5 offset:16896
  ds_read_b64_tr_b16 v[104:105], v4 offset:24576
  ds_read_b64_tr_b16 v[106:107], v4 offset:25088
  ds_read_b64_tr_b16 v[108:109], v5 offset:24576
  ds_read_b64_tr_b16 v[110:111], v5 offset:25088
  ds_read_b64_tr_b16 v[112:113], v4 offset:32768
  ds_read_b64_tr_b16 v[114:115], v4 offset:33280
  ds_read_b64_tr_b16 v[116:117], v5 offset:32768
  ds_read_b64_tr_b16 v[118:119], v5 offset:33280
  ds_read_b64_tr_b16 v[120:121], v4 offset:40960
  ds_read_b64_tr_b16 v[122:123], v4 offset:41472
  ds_read_b64_tr_b16 v[124:125], v5 offset:40960
  ds_read_b64_tr_b16 v[126:127], v5 offset:41472
  ds_read_b64_tr_b16 v[128:129], v4 offset:49152
  ds_read_b64_tr_b16 v[130:131], v4 offset:49664
  ds_read_b64_tr_b16 v[132:133], v5 offset:49152
  ds_read_b64_tr_b16 v[134:135], v5 offset:49664
  v_add_u32 v4, 57344, v4
  v_add_u32 v5, 57344, v5
  ds_read_b64_tr_b16 v[136:137], v4 offset:0
  ds_read_b64_tr_b16 v[138:139], v4 offset:512
  ds_read_b64_tr_b16 v[140:141], v5 offset:0
  ds_read_b64_tr_b16 v[142:143], v5 offset:512
  ds_read_b64_tr_b16 v[144:145], v4 offset:8192
  ds_read_b64_tr_b16 v[146:147], v4 offset:8704
  ds_read_b64_tr_b16 v[148:149], v5 offset:8192
  ds_read_b64_tr_b16 v[150:151], v5 offset:8704
  ds_read_b64_tr_b16 v[152:153], v4 offset:16384
  ds_read_b64_tr_b16 v[154:155], v4 offset:16896
  ds_read_b64_tr_b16 v[156:157], v5 offset:16384
  ds_read_b64_tr_b16 v[158:159], v5 offset:16896
  ds_read_b64_tr_b16 v[160:161], v4 offset:24576
  ds_read_b64_tr_b16 v[162:163], v4 offset:25088
  ds_read_b64_tr_b16 v[164:165], v5 offset:24576
  ds_read_b64_tr_b16 v[166:167], v5 offset:25088
  ds_read_b64_tr_b16 v[168:169], v4 offset:32768
  ds_read_b64_tr_b16 v[170:171], v4 offset:33280
  ds_read_b64_tr_b16 v[172:173], v5 offset:32768
  ds_read_b64_tr_b16 v[174:175], v5 offset:33280
  ds_read_b64_tr_b16 v[176:177], v4 offset:40960
  ds_read_b64_tr_b16 v[178:179], v4 offset:41472
  ds_read_b64_tr_b16 v[180:181], v5 offset:40960
  ds_read_b64_tr_b16 v[182:183], v5 offset:41472
  ds_read_b64_tr_b16 v[184:185], v4 offset:49152
  ds_read_b64_tr_b16 v[186:187], v4 offset:49664
  ds_read_b64_tr_b16 v[188:189], v5 offset:49152
  ds_read_b64_tr_b16 v[190:191], v5 offset:49664
  v_lshrrev_b32 v40, 4, v7
  v_and_b32 v41, 15, v7
  v_lshlrev_b32 v42, 4, v41
  v_lshl_add_u32 v42, v40, 9, v42
  s_mul_i32 s7, s86, 14336
  v_add_u32 v0, s7, v42
  v_add_u32 v1, 57344, v0
  v_mov_b32 v43, 6144
  v_mov_b32 v44, 27648
  v_cmp_gt_u32 vcc, 32, v7
  s_nop 1
  v_cndmask_b32 v43, v44, v43, vcc
  v_add_u32 v2, v43, v0
  v_add_u32 v3, v43, v1
  s_waitcnt vmcnt(0)
  v_mov_b32 v40, 161772
  v_mov_b32 v41, 1
  s_mov_b64 exec, 1
  ds_add_rtn_u32 v42, v40, v41
  s_mov_b64 exec, -1
  s_waitcnt lgkmcnt(0)
  v_readfirstlane_b32 s6, v42
  s_nop 1
  s_cmp_lg_u32 s6, 3
  s_cbranch_scc1 L_arr_51
  v_mov_b32 v40, s74
  v_mov_b32 v41, s75
  v_mov_b32 v42, 0
  s_lshl_b32 s6, s78, 4
  s_add_u32 s6, s6, 14462976
  s_mov_b64 exec, 1
  buffer_store_dwordx2 v[40:41], v42, s[44:47], s6 offen sc1
  s_mov_b64 exec, -1
L_arr_51:
  s_waitcnt lgkmcnt(0)
  s_barrier
  v_subrev_u32 v4, 8192, v4
  v_subrev_u32 v5, 8192, v5
  s_barrier
  ds_read_b64_tr_b16 v[192:193], v4 offset:0
  ds_read_b64_tr_b16 v[194:195], v4 offset:512
  ds_read_b64_tr_b16 v[196:197], v5 offset:0
  ds_read_b64_tr_b16 v[198:199], v5 offset:512
  ds_read_b64_tr_b16 v[200:201], v4 offset:8192
  ds_read_b64_tr_b16 v[202:203], v4 offset:8704
  ds_read_b64_tr_b16 v[204:205], v5 offset:8192
  ds_read_b64_tr_b16 v[206:207], v5 offset:8704
  ds_read_b64_tr_b16 v[208:209], v4 offset:16384
  ds_read_b64_tr_b16 v[210:211], v4 offset:16896
  ds_read_b64_tr_b16 v[212:213], v5 offset:16384
  ds_read_b64_tr_b16 v[214:215], v5 offset:16896
  ds_read_b64_tr_b16 v[216:217], v4 offset:24576
  ds_read_b64_tr_b16 v[218:219], v4 offset:25088
  ds_read_b64_tr_b16 v[220:221], v5 offset:24576
  ds_read_b64_tr_b16 v[222:223], v5 offset:25088
  ds_read_b64_tr_b16 v[224:225], v4 offset:32768
  ds_read_b64_tr_b16 v[226:227], v4 offset:33280
  ds_read_b64_tr_b16 v[228:229], v5 offset:32768
  ds_read_b64_tr_b16 v[230:231], v5 offset:33280
  ds_read_b64_tr_b16 v[232:233], v4 offset:40960
  ds_read_b64_tr_b16 v[234:235], v4 offset:41472
  ds_read_b64_tr_b16 v[236:237], v5 offset:40960
  ds_read_b64_tr_b16 v[238:239], v5 offset:41472
  ds_read_b64_tr_b16 v[240:241], v4 offset:49152
  ds_read_b64_tr_b16 v[242:243], v4 offset:49664
  ds_read_b64_tr_b16 v[244:245], v5 offset:49152
  ds_read_b64_tr_b16 v[246:247], v5 offset:49664
  ds_read_b64_tr_b16 v[248:249], v4 offset:57344
  ds_read_b64_tr_b16 v[250:251], v4 offset:57856
  ds_read_b64_tr_b16 v[252:253], v5 offset:57344
  ds_read_b64_tr_b16 v[254:255], v5 offset:57856
  v_add_u32 v4, 65536, v4
  v_add_u32 v5, 65536, v5
  s_mov_b32 s56, s36
  s_mov_b32 s57, s37
  s_mov_b32 s58, 2097152
  s_mov_b32 s59, 0x00020000
  v_lshlrev_b32 v40, 4, v7
  s_lshl_b32 s6, s4, 12
  s_add_u32 s6, s6, 122880
  v_add_u32 v72, s6, v40
  v_xor_b32 v73, 4096, v72
  v_lshrrev_b32 v41, 2, v7
  v_lshlrev_b32 v41, 7, v41
  v_and_b32 v42, 3, v7
  v_lshl_add_u32 v41, v42, 3, v41
  v_bfe_u32 v42, v7, 3, 2
  s_lshl_b32 s6, s86, 1
  v_xor_b32 v42, s6, v42
  s_lshl_b32 s7, s87, 12
  s_add_u32 s7, s7, 114688
  v_add_u32 v41, s7, v41
  v_lshl_add_u32 v74, v42, 5, v41
  v_xor_b32 v75, 32, v74
  v_and_b32 v41, 15, v7
  v_lshlrev_b32 v41, 10, v41
  v_bfe_u32 v42, v7, 4, 1
  v_lshl_add_u32 v41, v42, 5, v41
  v_lshrrev_b32 v42, 5, v7
  v_lshl_add_u32 v76, v42, 4, v41
  s_lshl_b32 s8, s76, 7
  s_lshr_b32 s7, s77, 3
  s_lshl_b32 s7, s7, 6
  s_add_u32 s8, s8, s7
  s_lshl_b32 s7, s86, 5
  s_add_u32 s8, s8, s7
  s_lshl_b32 s8, s8, 10
  s_and_b32 s7, s77, 7
  s_lshl_b32 s7, s7, 7
  s_add_u32 s8, s8, s7
  s_lshl_b32 s7, s87, 6
  s_add_u32 s8, s8, s7
  s_add_u32 s9, s8, 16384
  s_waitcnt lgkmcnt(0)
  s_barrier
  s_barrier
  ds_read_b128 v[40:43], v0 offset:0
  ds_read_b128 v[44:47], v0 offset:256
  ds_read_b128 v[48:51], v0 offset:7168
  ds_read_b128 v[52:55], v0 offset:7424
  s_waitcnt lgkmcnt(0)
  v_mfma_f32_16x16x32_bf16 v[8:11], v[80:83], v[40:43], 0
  ds_read_b128 v[56:59], v0 offset:2048
  v_mfma_f32_16x16x32_bf16 v[12:15], v[80:83], v[44:47], 0
  ds_read_b128 v[60:63], v0 offset:2304
  v_mfma_f32_16x16x32_bf16 v[16:19], v[80:83], v[48:51], 0
  ds_read_b128 v[64:67], v0 offset:9216
  v_mfma_f32_16x16x32_bf16 v[20:23], v[80:83], v[52:55], 0
  ds_read_b128 v[68:71], v0 offset:9472
  v_mfma_f32_16x16x32_bf16 v[24:27], v[84:87], v[40:43], 0
  v_mfma_f32_16x16x32_bf16 v[28:31], v[84:87], v[44:47], 0
  v_mfma_f32_16x16x32_bf16 v[32:35], v[84:87], v[48:51], 0
  v_mfma_f32_16x16x32_bf16 v[36:39], v[84:87], v[52:55], 0
  s_waitcnt lgkmcnt(0)
  v_mfma_f32_16x16x32_bf16 v[8:11], v[88:91], v[56:59], v[8:11]
  ds_read_b128 v[40:43], v0 offset:4096
  v_mfma_f32_16x16x32_bf16 v[12:15], v[88:91], v[60:63], v[12:15]
  ds_read_b128 v[44:47], v0 offset:4352
  v_mfma_f32_16x16x32_bf16 v[16:19], v[88:91], v[64:67], v[16:19]
  ds_read_b128 v[48:51], v0 offset:11264
  v_mfma_f32_16x16x32_bf16 v[20:23], v[88:91], v[68:71], v[20:23]
  ds_read_b128 v[52:55], v0 offset:11520
  v_mfma_f32_16x16x32_bf16 v[24:27], v[92:95], v[56:59], v[24:27]
  v_mfma_f32_16x16x32_bf16 v[28:31], v[92:95], v[60:63], v[28:31]
  v_mfma_f32_16x16x32_bf16 v[32:35], v[92:95], v[64:67], v[32:35]
  v_mfma_f32_16x16x32_bf16 v[36:39], v[92:95], v[68:71], v[36:39]
  s_waitcnt lgkmcnt(0)
  s_barrier
  v_mfma_f32_16x16x32_bf16 v[8:11], v[96:99], v[40:43], v[8:11]
  ds_read_b128 v[56:59], v2 offset:0
  v_mfma_f32_16x16x32_bf16 v[12:15], v[96:99], v[44:47], v[12:15]
  ds_read_b128 v[60:63], v2 offset:256
  v_mfma_f32_16x16x32_bf16 v[16:19], v[96:99], v[48:51], v[16:19]
  ds_read_b128 v[64:67], v2 offset:7168
  v_mfma_f32_16x16x32_bf16 v[20:23], v[96:99], v[52:55], v[20:23]
  ds_read_b128 v[68:71], v2 offset:7424
  v_mfma_f32_16x16x32_bf16 v[24:27], v[100:103], v[40:43], v[24:27]
  v_mfma_f32_16x16x32_bf16 v[28:31], v[100:103], v[44:47], v[28:31]
  v_mfma_f32_16x16x32_bf16 v[32:35], v[100:103], v[48:51], v[32:35]
  v_mfma_f32_16x16x32_bf16 v[36:39], v[100:103], v[52:55], v[36:39]
  s_waitcnt lgkmcnt(0)
  v_mfma_f32_16x16x32_bf16 v[8:11], v[104:107], v[56:59], v[8:11]
  ds_read_b128 v[40:43], v0 offset:29696
  v_mfma_f32_16x16x32_bf16 v[12:15], v[104:107], v[60:63], v[12:15]
  ds_read_b128 v[44:47], v0 offset:29952
  v_mfma_f32_16x16x32_bf16 v[16:19], v[104:107], v[64:67], v[16:19]
  ds_read_b128 v[48:51], v0 offset:36864
  v_mfma_f32_16x16x32_bf16 v[20:23], v[104:107], v[68:71], v[20:23]
  ds_read_b128 v[52:55], v0 offset:37120
  v_mfma_f32_16x16x32_bf16 v[24:27], v[108:111], v[56:59], v[24:27]
  v_mfma_f32_16x16x32_bf16 v[28:31], v[108:111], v[60:63], v[28:31]
  v_mfma_f32_16x16x32_bf16 v[32:35], v[108:111], v[64:67], v[32:35]
  v_mfma_f32_16x16x32_bf16 v[36:39], v[108:111], v[68:71], v[36:39]
  s_waitcnt lgkmcnt(0)
  v_mfma_f32_16x16x32_bf16 v[8:11], v[112:115], v[40:43], v[8:11]
  ds_read_b128 v[56:59], v0 offset:31744
  v_mfma_f32_16x16x32_bf16 v[12:15], v[112:115], v[44:47], v[12:15]
  ds_read_b128 v[60:63], v0 offset:32000
  v_mfma_f32_16x16x32_bf16 v[16:19], v[112:115], v[48:51], v[16:19]
  ds_read_b128 v[64:67], v0 offset:38912
  v_mfma_f32_16x16x32_bf16 v[20:23], v[112:115], v[52:55], v[20:23]
  ds_read_b128 v[68:71], v0 offset:39168
  v_mfma_f32_16x16x32_bf16 v[24:27], v[116:119], v[40:43], v[24:27]
  v_mfma_f32_16x16x32_bf16 v[28:31], v[116:119], v[44:47], v[28:31]
  v_mfma_f32_16x16x32_bf16 v[32:35], v[116:119], v[48:51], v[32:35]
  v_mfma_f32_16x16x32_bf16 v[36:39], v[116:119], v[52:55], v[36:39]
  s_waitcnt lgkmcnt(0)
  v_mfma_f32_16x16x32_bf16 v[8:11], v[120:123], v[56:59], v[8:11]
  ds_read_b128 v[40:43], v0 offset:33792
  v_mfma_f32_16x16x32_bf16 v[12:15], v[120:123], v[60:63], v[12:15]
  ds_read_b128 v[44:47], v0 offset:34048
  v_mfma_f32_16x16x32_bf16 v[16:19], v[120:123], v[64:67], v[16:19]
  ds_read_b128 v[48:51], v0 offset:40960
  v_mfma_f32_16x16x32_bf16 v[20:23], v[120:123], v[68:71], v[20:23]
  ds_read_b128 v[52:55], v0 offset:41216
  v_mfma_f32_16x16x32_bf16 v[24:27], v[124:127], v[56:59], v[24:27]
  v_mfma_f32_16x16x32_bf16 v[28:31], v[124:127], v[60:63], v[28:31]
  v_mfma_f32_16x16x32_bf16 v[32:35], v[124:127], v[64:67], v[32:35]
  v_mfma_f32_16x16x32_bf16 v[36:39], v[124:127], v[68:71], v[36:39]
  s_waitcnt lgkmcnt(0)
  s_barrier
  v_mfma_f32_16x16x32_bf16 v[8:11], v[128:131], v[40:43], v[8:11]
  ds_read_b128 v[56:59], v1 offset:0
  v_mfma_f32_16x16x32_bf16 v[12:15], v[128:131], v[44:47], v[12:15]
  ds_read_b128 v[60:63], v1 offset:256
  v_mfma_f32_16x16x32_bf16 v[16:19], v[128:131], v[48:51], v[16:19]
  ds_read_b128 v[64:67], v1 offset:7168
  v_mfma_f32_16x16x32_bf16 v[20:23], v[128:131], v[52:55], v[20:23]
  ds_read_b128 v[68:71], v1 offset:7424
  v_mfma_f32_16x16x32_bf16 v[24:27], v[132:135], v[40:43], v[24:27]
  ds_read_b64_tr_b16 v[80:81], v4 offset:0
  v_mfma_f32_16x16x32_bf16 v[28:31], v[132:135], v[44:47], v[28:31]
  ds_read_b64_tr_b16 v[82:83], v4 offset:512
  v_mfma_f32_16x16x32_bf16 v[32:35], v[132:135], v[48:51], v[32:35]
  ds_read_b64_tr_b16 v[84:85], v5 offset:0
  v_mfma_f32_16x16x32_bf16 v[36:39], v[132:135], v[52:55], v[36:39]
  ds_read_b64_tr_b16 v[86:87], v5 offset:512
  s_waitcnt lgkmcnt(4)
  v_mfma_f32_16x16x32_bf16 v[8:11], v[136:139], v[56:59], v[8:11]
  ds_read_b128 v[40:43], v1 offset:2048
  v_mfma_f32_16x16x32_bf16 v[12:15], v[136:139], v[60:63], v[12:15]
  ds_read_b128 v[44:47], v1 offset:2304
  v_mfma_f32_16x16x32_bf16 v[16:19], v[136:139], v[64:67], v[16:19]
  ds_read_b128 v[48:51], v1 offset:9216
  v_mfma_f32_16x16x32_bf16 v[20:23], v[136:139], v[68:71], v[20:23]
  ds_read_b128 v[52:55], v1 offset:9472
  v_mfma_f32_16x16x32_bf16 v[24:27], v[140:143], v[56:59], v[24:27]
  ds_read_b64_tr_b16 v[88:89], v4 offset:8192
  v_mfma_f32_16x16x32_bf16 v[28:31], v[140:143], v[60:63], v[28:31]
  ds_read_b64_tr_b16 v[90:91], v4 offset:8704
  v_mfma_f32_16x16x32_bf16 v[32:35], v[140:143], v[64:67], v[32:35]
  ds_read_b64_tr_b16 v[92:93], v5 offset:8192
  v_mfma_f32_16x16x32_bf16 v[36:39], v[140:143], v[68:71], v[36:39]
  ds_read_b64_tr_b16 v[94:95], v5 offset:8704
  s_waitcnt lgkmcnt(4)
  v_mfma_f32_16x16x32_bf16 v[8:11], v[144:147], v[40:43], v[8:11]
  ds_read_b128 v[56:59], v1 offset:4096
  v_mfma_f32_16x16x32_bf16 v[12:15], v[144:147], v[44:47], v[12:15]
  ds_read_b128 v[60:63], v1 offset:4352
  v_mfma_f32_16x16x32_bf16 v[16:19], v[144:147], v[48:51], v[16:19]
  ds_read_b128 v[64:67], v1 offset:11264
  v_mfma_f32_16x16x32_bf16 v[20:23], v[144:147], v[52:55], v[20:23]
  ds_read_b128 v[68:71], v1 offset:11520
  v_mfma_f32_16x16x32_bf16 v[24:27], v[148:151], v[40:43], v[24:27]
  ds_read_b64_tr_b16 v[96:97], v4 offset:16384
  v_mfma_f32_16x16x32_bf16 v[28:31], v[148:151], v[44:47], v[28:31]
  ds_read_b64_tr_b16 v[98:99], v4 offset:16896
  v_mfma_f32_16x16x32_bf16 v[32:35], v[148:151], v[48:51], v[32:35]
  ds_read_b64_tr_b16 v[100:101], v5 offset:16384
  v_mfma_f32_16x16x32_bf16 v[36:39], v[148:151], v[52:55], v[36:39]
  ds_read_b64_tr_b16 v[102:103], v5 offset:16896
  s_waitcnt lgkmcnt(4)
  s_barrier
  v_mfma_f32_16x16x32_bf16 v[8:11], v[152:155], v[56:59], v[8:11]
  ds_read_b128 v[40:43], v3 offset:0
  v_mfma_f32_16x16x32_bf16 v[12:15], v[152:155], v[60:63], v[12:15]
  ds_read_b128 v[44:47], v3 offset:256
  v_mfma_f32_16x16x32_bf16 v[16:19], v[152:155], v[64:67], v[16:19]
  ds_read_b128 v[48:51], v3 offset:7168
  v_mfma_f32_16x16x32_bf16 v[20:23], v[152:155], v[68:71], v[20:23]
  ds_read_b128 v[52:55], v3 offset:7424
  v_mfma_f32_16x16x32_bf16 v[24:27], v[156:159], v[56:59], v[24:27]
  ds_read_b64_tr_b16 v[104:105], v4 offset:24576
  v_mfma_f32_16x16x32_bf16 v[28:31], v[156:159], v[60:63], v[28:31]
  ds_read_b64_tr_b16 v[106:107], v4 offset:25088
  v_mfma_f32_16x16x32_bf16 v[32:35], v[156:159], v[64:67], v[32:35]
  ds_read_b64_tr_b16 v[108:109], v5 offset:24576
  v_mfma_f32_16x16x32_bf16 v[36:39], v[156:159], v[68:71], v[36:39]
  ds_read_b64_tr_b16 v[110:111], v5 offset:25088
  s_waitcnt lgkmcnt(4)
  v_mfma_f32_16x16x32_bf16 v[8:11], v[160:163], v[40:43], v[8:11]
  ds_read_b128 v[56:59], v1 offset:29696
  v_mfma_f32_16x16x32_bf16 v[12:15], v[160:163], v[44:47], v[12:15]
  ds_read_b128 v[60:63], v1 offset:29952
  v_mfma_f32_16x16x32_bf16 v[16:19], v[160:163], v[48:51], v[16:19]
  ds_read_b128 v[64:67], v1 offset:36864
  v_mfma_f32_16x16x32_bf16 v[20:23], v[160:163], v[52:55], v[20:23]
  ds_read_b128 v[68:71], v1 offset:37120
  v_mfma_f32_16x16x32_bf16 v[24:27], v[164:167], v[40:43], v[24:27]
  ds_read_b64_tr_b16 v[112:113], v4 offset:32768
  v_mfma_f32_16x16x32_bf16 v[28:31], v[164:167], v[44:47], v[28:31]
  ds_read_b64_tr_b16 v[114:115], v4 offset:33280
  v_mfma_f32_16x16x32_bf16 v[32:35], v[164:167], v[48:51], v[32:35]
  ds_read_b64_tr_b16 v[116:117], v5 offset:32768
  v_mfma_f32_16x16x32_bf16 v[36:39], v[164:167], v[52:55], v[36:39]
  ds_read_b64_tr_b16 v[118:119], v5 offset:33280
  s_waitcnt lgkmcnt(4)
  v_mfma_f32_16x16x32_bf16 v[8:11], v[168:171], v[56:59], v[8:11]
  ds_read_b128 v[40:43], v1 offset:31744
  v_mfma_f32_16x16x32_bf16 v[12:15], v[168:171], v[60:63], v[12:15]
  ds_read_b128 v[44:47], v1 offset:32000
  v_mfma_f32_16x16x32_bf16 v[16:19], v[168:171], v[64:67], v[16:19]
  ds_read_b128 v[48:51], v1 offset:38912
  v_mfma_f32_16x16x32_bf16 v[20:23], v[168:171], v[68:71], v[20:23]
  ds_read_b128 v[52:55], v1 offset:39168
  v_mfma_f32_16x16x32_bf16 v[24:27], v[172:175], v[56:59], v[24:27]
  ds_read_b64_tr_b16 v[120:121], v4 offset:40960
  v_mfma_f32_16x16x32_bf16 v[28:31], v[172:175], v[60:63], v[28:31]
  ds_read_b64_tr_b16 v[122:123], v4 offset:41472
  v_mfma_f32_16x16x32_bf16 v[32:35], v[172:175], v[64:67], v[32:35]
  ds_read_b64_tr_b16 v[124:125], v5 offset:40960
  v_mfma_f32_16x16x32_bf16 v[36:39], v[172:175], v[68:71], v[36:39]
  ds_read_b64_tr_b16 v[126:127], v5 offset:41472
  s_waitcnt lgkmcnt(4)
  v_mfma_f32_16x16x32_bf16 v[8:11], v[176:179], v[40:43], v[8:11]
  ds_read_b128 v[56:59], v1 offset:33792
  v_mfma_f32_16x16x32_bf16 v[12:15], v[176:179], v[44:47], v[12:15]
  ds_read_b128 v[60:63], v1 offset:34048
  v_mfma_f32_16x16x32_bf16 v[16:19], v[176:179], v[48:51], v[16:19]
  ds_read_b128 v[64:67], v1 offset:40960
  v_mfma_f32_16x16x32_bf16 v[20:23], v[176:179], v[52:55], v[20:23]
  ds_read_b128 v[68:71], v1 offset:41216
  v_mfma_f32_16x16x32_bf16 v[24:27], v[180:183], v[40:43], v[24:27]
  v_mfma_f32_16x16x32_bf16 v[28:31], v[180:183], v[44:47], v[28:31]
  v_mfma_f32_16x16x32_bf16 v[32:35], v[180:183], v[48:51], v[32:35]
  v_mfma_f32_16x16x32_bf16 v[36:39], v[180:183], v[52:55], v[36:39]
  s_waitcnt lgkmcnt(0)
  s_barrier
  v_mfma_f32_16x16x32_bf16 v[8:11], v[184:187], v[56:59], v[8:11]
  ds_read_b128 v[40:43], v0 offset:0
  v_mfma_f32_16x16x32_bf16 v[12:15], v[184:187], v[60:63], v[12:15]
  ds_read_b128 v[44:47], v0 offset:256
  v_mfma_f32_16x16x32_bf16 v[16:19], v[184:187], v[64:67], v[16:19]
  ds_read_b128 v[48:51], v0 offset:7168
  v_mfma_f32_16x16x32_bf16 v[20:23], v[184:187], v[68:71], v[20:23]
  ds_read_b128 v[52:55], v0 offset:7424
  v_mfma_f32_16x16x32_bf16 v[24:27], v[188:191], v[56:59], v[24:27]
  v_mfma_f32_16x16x32_bf16 v[28:31], v[188:191], v[60:63], v[28:31]
  v_mfma_f32_16x16x32_bf16 v[32:35], v[188:191], v[64:67], v[32:35]
  v_mfma_f32_16x16x32_bf16 v[36:39], v[188:191], v[68:71], v[36:39]
  s_waitcnt lgkmcnt(0)
  v_mfma_f32_16x16x32_bf16 v[8:11], v[192:195], v[40:43], v[8:11]
  ds_read_b128 v[56:59], v0 offset:2048
  v_mfma_f32_16x16x32_bf16 v[12:15], v[192:195], v[44:47], v[12:15]
  ds_read_b128 v[60:63], v0 offset:2304
  v_mfma_f32_16x16x32_bf16 v[16:19], v[192:195], v[48:51], v[16:19]
  ds_read_b128 v[64:67], v0 offset:9216
  v_mfma_f32_16x16x32_bf16 v[20:23], v[192:195], v[52:55], v[20:23]
  ds_read_b128 v[68:71], v0 offset:9472
  v_mfma_f32_16x16x32_bf16 v[24:27], v[196:199], v[40:43], v[24:27]
  v_mfma_f32_16x16x32_bf16 v[28:31], v[196:199], v[44:47], v[28:31]
  v_mfma_f32_16x16x32_bf16 v[32:35], v[196:199], v[48:51], v[32:35]
  v_mfma_f32_16x16x32_bf16 v[36:39], v[196:199], v[52:55], v[36:39]
  s_waitcnt lgkmcnt(0)
  v_mfma_f32_16x16x32_bf16 v[8:11], v[200:203], v[56:59], v[8:11]
  ds_read_b128 v[40:43], v0 offset:4096
  v_mfma_f32_16x16x32_bf16 v[12:15], v[200:203], v[60:63], v[12:15]
  ds_read_b128 v[44:47], v0 offset:4352
  v_mfma_f32_16x16x32_bf16 v[16:19], v[200:203], v[64:67], v[16:19]
  ds_read_b128 v[48:51], v0 offset:11264
  v_mfma_f32_16x16x32_bf16 v[20:23], v[200:203], v[68:71], v[20:23]
  ds_read_b128 v[52:55], v0 offset:11520
  v_mfma_f32_16x16x32_bf16 v[24:27], v[204:207], v[56:59], v[24:27]
  v_mfma_f32_16x16x32_bf16 v[28:31], v[204:207], v[60:63], v[28:31]
  v_mfma_f32_16x16x32_bf16 v[32:35], v[204:207], v[64:67], v[32:35]
  v_mfma_f32_16x16x32_bf16 v[36:39], v[204:207], v[68:71], v[36:39]
  s_waitcnt lgkmcnt(0)
  s_barrier
  v_mfma_f32_16x16x32_bf16 v[8:11], v[208:211], v[40:43], v[8:11]
  ds_read_b128 v[56:59], v2 offset:0
  v_mfma_f32_16x16x32_bf16 v[12:15], v[208:211], v[44:47], v[12:15]
  ds_read_b128 v[60:63], v2 offset:256
  v_mfma_f32_16x16x32_bf16 v[16:19], v[208:211], v[48:51], v[16:19]
  ds_read_b128 v[64:67], v2 offset:7168
  v_mfma_f32_16x16x32_bf16 v[20:23], v[208:211], v[52:55], v[20:23]
  ds_read_b128 v[68:71], v2 offset:7424
  v_mfma_f32_16x16x32_bf16 v[24:27], v[212:215], v[40:43], v[24:27]
  v_mfma_f32_16x16x32_bf16 v[28:31], v[212:215], v[44:47], v[28:31]
  v_mfma_f32_16x16x32_bf16 v[32:35], v[212:215], v[48:51], v[32:35]
  v_mfma_f32_16x16x32_bf16 v[36:39], v[212:215], v[52:55], v[36:39]
  s_waitcnt lgkmcnt(0)
  v_mfma_f32_16x16x32_bf16 v[8:11], v[216:219], v[56:59], v[8:11]
  ds_read_b128 v[40:43], v0 offset:29696
  v_mfma_f32_16x16x32_bf16 v[12:15], v[216:219], v[60:63], v[12:15]
  ds_read_b128 v[44:47], v0 offset:29952
  v_mfma_f32_16x16x32_bf16 v[16:19], v[216:219], v[64:67], v[16:19]
  ds_read_b128 v[48:51], v0 offset:36864
  v_mfma_f32_16x16x32_bf16 v[20:23], v[216:219], v[68:71], v[20:23]
  ds_read_b128 v[52:55], v0 offset:37120
  v_mfma_f32_16x16x32_bf16 v[24:27], v[220:223], v[56:59], v[24:27]
  v_mfma_f32_16x16x32_bf16 v[28:31], v[220:223], v[60:63], v[28:31]
  v_mfma_f32_16x16x32_bf16 v[32:35], v[220:223], v[64:67], v[32:35]
  v_mfma_f32_16x16x32_bf16 v[36:39], v[220:223], v[68:71], v[36:39]
  s_waitcnt lgkmcnt(0)
  v_mfma_f32_16x16x32_bf16 v[8:11], v[224:227], v[40:43], v[8:11]
  ds_read_b128 v[56:59], v0 offset:31744
  v_mfma_f32_16x16x32_bf16 v[12:15], v[224:227], v[44:47], v[12:15]
  ds_read_b128 v[60:63], v0 offset:32000
  v_mfma_f32_16x16x32_bf16 v[16:19], v[224:227], v[48:51], v[16:19]
  ds_read_b128 v[64:67], v0 offset:38912
  v_mfma_f32_16x16x32_bf16 v[20:23], v[224:227], v[52:55], v[20:23]
  ds_read_b128 v[68:71], v0 offset:39168
  v_mfma_f32_16x16x32_bf16 v[24:27], v[228:231], v[40:43], v[24:27]
  v_mfma_f32_16x16x32_bf16 v[28:31], v[228:231], v[44:47], v[28:31]
  v_mfma_f32_16x16x32_bf16 v[32:35], v[228:231], v[48:51], v[32:35]
  v_mfma_f32_16x16x32_bf16 v[36:39], v[228:231], v[52:55], v[36:39]
  s_waitcnt lgkmcnt(0)
  v_mfma_f32_16x16x32_bf16 v[8:11], v[232:235], v[56:59], v[8:11]
  ds_read_b128 v[40:43], v0 offset:33792
  v_mfma_f32_16x16x32_bf16 v[12:15], v[232:235], v[60:63], v[12:15]
  ds_read_b128 v[44:47], v0 offset:34048
  v_mfma_f32_16x16x32_bf16 v[16:19], v[232:235], v[64:67], v[16:19]
  ds_read_b128 v[48:51], v0 offset:40960
  v_mfma_f32_16x16x32_bf16 v[20:23], v[232:235], v[68:71], v[20:23]
  ds_read_b128 v[52:55], v0 offset:41216
  v_mfma_f32_16x16x32_bf16 v[24:27], v[236:239], v[56:59], v[24:27]
  v_mfma_f32_16x16x32_bf16 v[28:31], v[236:239], v[60:63], v[28:31]
  v_mfma_f32_16x16x32_bf16 v[32:35], v[236:239], v[64:67], v[32:35]
  v_mfma_f32_16x16x32_bf16 v[36:39], v[236:239], v[68:71], v[36:39]
  s_waitcnt lgkmcnt(0)
  s_barrier
  v_mfma_f32_16x16x32_bf16 v[8:11], v[240:243], v[40:43], v[8:11]
  ds_read_b128 v[56:59], v1 offset:0
  v_mfma_f32_16x16x32_bf16 v[12:15], v[240:243], v[44:47], v[12:15]
  ds_read_b128 v[60:63], v1 offset:256
  v_mfma_f32_16x16x32_bf16 v[16:19], v[240:243], v[48:51], v[16:19]
  ds_read_b128 v[64:67], v1 offset:7168
  v_mfma_f32_16x16x32_bf16 v[20:23], v[240:243], v[52:55], v[20:23]
  ds_read_b128 v[68:71], v1 offset:7424
  v_mfma_f32_16x16x32_bf16 v[24:27], v[244:247], v[40:43], v[24:27]
  v_mfma_f32_16x16x32_bf16 v[28:31], v[244:247], v[44:47], v[28:31]
  v_mfma_f32_16x16x32_bf16 v[32:35], v[244:247], v[48:51], v[32:35]
  v_mfma_f32_16x16x32_bf16 v[36:39], v[244:247], v[52:55], v[36:39]
  s_waitcnt lgkmcnt(0)
  v_mfma_f32_16x16x32_bf16 v[8:11], v[248:251], v[56:59], v[8:11]
  ds_read_b128 v[40:43], v1 offset:2048
  v_mfma_f32_16x16x32_bf16 v[12:15], v[248:251], v[60:63], v[12:15]
  ds_read_b128 v[44:47], v1 offset:2304
  v_mfma_f32_16x16x32_bf16 v[16:19], v[248:251], v[64:67], v[16:19]
  ds_read_b128 v[48:51], v1 offset:9216
  v_mfma_f32_16x16x32_bf16 v[20:23], v[248:251], v[68:71], v[20:23]
  ds_read_b128 v[52:55], v1 offset:9472
  v_mfma_f32_16x16x32_bf16 v[24:27], v[252:255], v[56:59], v[24:27]
  v_mfma_f32_16x16x32_bf16 v[28:31], v[252:255], v[60:63], v[28:31]
  v_mfma_f32_16x16x32_bf16 v[32:35], v[252:255], v[64:67], v[32:35]
  v_mfma_f32_16x16x32_bf16 v[36:39], v[252:255], v[68:71], v[36:39]
  s_waitcnt lgkmcnt(0)
  v_mfma_f32_16x16x32_bf16 v[8:11], v[80:83], v[40:43], v[8:11]
  ds_read_b128 v[56:59], v1 offset:4096
  v_mfma_f32_16x16x32_bf16 v[12:15], v[80:83], v[44:47], v[12:15]
  ds_read_b128 v[60:63], v1 offset:4352
  v_mfma_f32_16x16x32_bf16 v[16:19], v[80:83], v[48:51], v[16:19]
  ds_read_b128 v[64:67], v1 offset:11264
  v_mfma_f32_16x16x32_bf16 v[20:23], v[80:83], v[52:55], v[20:23]
  ds_read_b128 v[68:71], v1 offset:11520
  v_mfma_f32_16x16x32_bf16 v[24:27], v[84:87], v[40:43], v[24:27]
  v_mfma_f32_16x16x32_bf16 v[28:31], v[84:87], v[44:47], v[28:31]
  v_mfma_f32_16x16x32_bf16 v[32:35], v[84:87], v[48:51], v[32:35]
  v_mfma_f32_16x16x32_bf16 v[36:39], v[84:87], v[52:55], v[36:39]
  s_waitcnt lgkmcnt(0)
  s_barrier
  v_mfma_f32_16x16x32_bf16 v[8:11], v[88:91], v[56:59], v[8:11]
  ds_read_b128 v[40:43], v3 offset:0
  v_mfma_f32_16x16x32_bf16 v[12:15], v[88:91], v[60:63], v[12:15]
  ds_read_b128 v[44:47], v3 offset:256
  v_mfma_f32_16x16x32_bf16 v[16:19], v[88:91], v[64:67], v[16:19]
  ds_read_b128 v[48:51], v3 offset:7168
  v_mfma_f32_16x16x32_bf16 v[20:23], v[88:91], v[68:71], v[20:23]
  ds_read_b128 v[52:55], v3 offset:7424
  v_mfma_f32_16x16x32_bf16 v[24:27], v[92:95], v[56:59], v[24:27]
  v_mfma_f32_16x16x32_bf16 v[28:31], v[92:95], v[60:63], v[28:31]
  v_mfma_f32_16x16x32_bf16 v[32:35], v[92:95], v[64:67], v[32:35]
  v_mfma_f32_16x16x32_bf16 v[36:39], v[92:95], v[68:71], v[36:39]
  s_waitcnt lgkmcnt(0)
  v_mfma_f32_16x16x32_bf16 v[8:11], v[96:99], v[40:43], v[8:11]
  ds_read_b128 v[56:59], v1 offset:29696
  v_mfma_f32_16x16x32_bf16 v[12:15], v[96:99], v[44:47], v[12:15]
  ds_read_b128 v[60:63], v1 offset:29952
  v_mfma_f32_16x16x32_bf16 v[16:19], v[96:99], v[48:51], v[16:19]
  ds_read_b128 v[64:67], v1 offset:36864
  v_mfma_f32_16x16x32_bf16 v[20:23], v[96:99], v[52:55], v[20:23]
  ds_read_b128 v[68:71], v1 offset:37120
  v_mfma_f32_16x16x32_bf16 v[24:27], v[100:103], v[40:43], v[24:27]
  v_mfma_f32_16x16x32_bf16 v[28:31], v[100:103], v[44:47], v[28:31]
  v_mfma_f32_16x16x32_bf16 v[32:35], v[100:103], v[48:51], v[32:35]
  v_mfma_f32_16x16x32_bf16 v[36:39], v[100:103], v[52:55], v[36:39]
  s_waitcnt lgkmcnt(0)
  v_mfma_f32_16x16x32_bf16 v[8:11], v[104:107], v[56:59], v[8:11]
  ds_read_b128 v[40:43], v1 offset:31744
  v_mfma_f32_16x16x32_bf16 v[12:15], v[104:107], v[60:63], v[12:15]
  ds_read_b128 v[44:47], v1 offset:32000
  v_mfma_f32_16x16x32_bf16 v[16:19], v[104:107], v[64:67], v[16:19]
  ds_read_b128 v[48:51], v1 offset:38912
  v_mfma_f32_16x16x32_bf16 v[20:23], v[104:107], v[68:71], v[20:23]
  ds_read_b128 v[52:55], v1 offset:39168
  v_mfma_f32_16x16x32_bf16 v[24:27], v[108:111], v[56:59], v[24:27]
  v_mfma_f32_16x16x32_bf16 v[28:31], v[108:111], v[60:63], v[28:31]
  v_mfma_f32_16x16x32_bf16 v[32:35], v[108:111], v[64:67], v[32:35]
  v_mfma_f32_16x16x32_bf16 v[36:39], v[108:111], v[68:71], v[36:39]
  s_waitcnt lgkmcnt(0)
  v_mfma_f32_16x16x32_bf16 v[8:11], v[112:115], v[40:43], v[8:11]
  ds_read_b128 v[56:59], v1 offset:33792
  v_mfma_f32_16x16x32_bf16 v[12:15], v[112:115], v[44:47], v[12:15]
  ds_read_b128 v[60:63], v1 offset:34048
  v_mfma_f32_16x16x32_bf16 v[16:19], v[112:115], v[48:51], v[16:19]
  ds_read_b128 v[64:67], v1 offset:40960
  v_mfma_f32_16x16x32_bf16 v[20:23], v[112:115], v[52:55], v[20:23]
  ds_read_b128 v[68:71], v1 offset:41216
  v_mfma_f32_16x16x32_bf16 v[24:27], v[116:119], v[40:43], v[24:27]
  v_mov_b32 v4, v72
  v_mfma_f32_16x16x32_bf16 v[28:31], v[116:119], v[44:47], v[28:31]
  v_mov_b32 v5, v73
  v_mfma_f32_16x16x32_bf16 v[32:35], v[116:119], v[48:51], v[32:35]
  v_mov_b32 v6, v74
  v_mov_b32 v7, v75
  v_mfma_f32_16x16x32_bf16 v[36:39], v[116:119], v[52:55], v[36:39]
  v_mov_b32 v0, v76
  s_waitcnt lgkmcnt(0)
  v_mfma_f32_16x16x32_bf16 v[8:11], v[120:123], v[56:59], v[8:11]
  ds_read_b64_tr_b16 v[72:73], v6 offset:0
  v_mfma_f32_16x16x32_bf16 v[12:15], v[120:123], v[60:63], v[12:15]
  ds_read_b64_tr_b16 v[76:77], v6 offset:2048
  v_mfma_f32_16x16x32_bf16 v[16:19], v[120:123], v[64:67], v[16:19]
  ds_read_b64_tr_b16 v[74:75], v7 offset:0
  v_mfma_f32_16x16x32_bf16 v[20:23], v[120:123], v[68:71], v[20:23]
  ds_read_b64_tr_b16 v[78:79], v7 offset:2048
  v_mfma_f32_16x16x32_bf16 v[24:27], v[124:127], v[56:59], v[24:27]
  v_mfma_f32_16x16x32_bf16 v[28:31], v[124:127], v[60:63], v[28:31]
  v_mfma_f32_16x16x32_bf16 v[32:35], v[124:127], v[64:67], v[32:35]
  v_mfma_f32_16x16x32_bf16 v[36:39], v[124:127], v[68:71], v[36:39]
  s_cmp_eq_u32 s86, 0
  s_nop 5
  s_cbranch_scc1 L_x2_52_k0
  ds_write_b128 v4, v[8:11] offset:0
  ds_write_b128 v4, v[12:15] offset:1024
  ds_write_b128 v4, v[24:27] offset:2048
  ds_write_b128 v4, v[28:31] offset:3072
  s_nop 1
  v_mov_b32 v8, v16
  v_mov_b32 v9, v17
  v_mov_b32 v10, v18
  v_mov_b32 v11, v19
  v_mov_b32 v12, v20
  v_mov_b32 v13, v21
  v_mov_b32 v14, v22
  v_mov_b32 v15, v23
  v_mov_b32 v24, v32
  v_mov_b32 v25, v33
  v_mov_b32 v26, v34
  v_mov_b32 v27, v35
  v_mov_b32 v28, v36
  v_mov_b32 v29, v37
  v_mov_b32 v30, v38
  v_mov_b32 v31, v39
  s_branch L_x2_52_done
L_x2_52_k0:
  ds_write_b128 v4, v[16:19] offset:0
  ds_write_b128 v4, v[20:23] offset:1024
  ds_write_b128 v4, v[32:35] offset:2048
  ds_write_b128 v4, v[36:39] offset:3072
L_x2_52_done:
  s_waitcnt lgkmcnt(4)
  v_lshlrev_b32 v56, 16, v72
  v_and_b32 v57, s64, v72
  v_lshlrev_b32 v58, 16, v73
  v_and_b32 v59, s64, v73
  v_pk_add_f32 v[8:9], v[8:9], v[56:57]
  v_pk_add_f32 v[10:11], v[10:11], v[58:59]
  v_lshlrev_b32 v60, 16, v76
  v_and_b32 v61, s64, v76
  v_lshlrev_b32 v62, 16, v77
  v_and_b32 v63, s64, v77
  v_pk_add_f32 v[24:25], v[24:25], v[60:61]
  v_pk_add_f32 v[26:27], v[26:27], v[62:63]
  v_lshlrev_b32 v64, 16, v74
  v_and_b32 v65, s64, v74
  v_lshlrev_b32 v66, 16, v75
  v_and_b32 v67, s64, v75
  v_pk_add_f32 v[12:13], v[12:13], v[64:65]
  v_pk_add_f32 v[14:15], v[14:15], v[66:67]
  v_lshlrev_b32 v68, 16, v78
  v_and_b32 v69, s64, v78
  v_lshlrev_b32 v70, 16, v79
  v_and_b32 v71, s64, v79
  v_pk_add_f32 v[28:29], v[28:29], v[68:69]
  v_pk_add_f32 v[30:31], v[30:31], v[70:71]
  s_waitcnt lgkmcnt(0)
  s_barrier
  ds_read_b128 v[40:43], v5 offset:0
  ds_read_b128 v[48:51], v5 offset:2048
  ds_read_b128 v[44:47], v5 offset:1024
  ds_read_b128 v[52:55], v5 offset:3072
  s_waitcnt lgkmcnt(2)
  v_pk_add_f32 v[8:9], v[8:9], v[40:41]
  v_pk_add_f32 v[10:11], v[10:11], v[42:43]
  v_pk_add_f32 v[24:25], v[24:25], v[48:49]
  v_pk_add_f32 v[26:27], v[26:27], v[50:51]
  v_cvt_pk_bf16_f32 v80, v8, v9
  v_cvt_pk_bf16_f32 v81, v10, v11
  v_cvt_pk_bf16_f32 v82, v24, v25
  v_cvt_pk_bf16_f32 v83, v26, v27
  s_nop 1
  v_permlane16_swap_b32 v80, v82
  v_permlane16_swap_b32 v81, v83
  buffer_store_dwordx4 v[80:83], v0, s[56:59], s8 offen
  s_waitcnt lgkmcnt(0)
  v_pk_add_f32 v[12:13], v[12:13], v[44:45]
  v_pk_add_f32 v[14:15], v[14:15], v[46:47]
  v_pk_add_f32 v[28:29], v[28:29], v[52:53]
  v_pk_add_f32 v[30:31], v[30:31], v[54:55]
  v_cvt_pk_bf16_f32 v84, v12, v13
  v_cvt_pk_bf16_f32 v85, v14, v15
  v_cvt_pk_bf16_f32 v86, v28, v29
  v_cvt_pk_bf16_f32 v87, v30, v31
  s_nop 1
  v_permlane16_swap_b32 v84, v86
  v_permlane16_swap_b32 v85, v87
  buffer_store_dwordx4 v[84:87], v0, s[56:59], s9 offen
  s_endpgm
L_end:
  s_endpgm
.section .rodata,"a"
.p2align 6
.amdhsa_kernel sequential_preLN__ssm_conv_h3__glu_gated_swiglu__prompt_kernel
  .amdhsa_next_free_vgpr 256
  .amdhsa_next_free_sgpr 102
  .amdhsa_accum_offset 256
  .amdhsa_group_segment_fixed_size 0
  .amdhsa_kernarg_size 104
  .amdhsa_user_sgpr_count 2
  .amdhsa_user_sgpr_kernarg_segment_ptr 1
  .amdhsa_system_sgpr_workgroup_id_x 1
.end_amdhsa_kernel
```
